```python
import torch

def _softmax(x, axis=-1):
    return torch.softmax(x, dim=axis)
def _gelu(x):
    return torch.nn.functional.gelu(x, approximate="tanh")
def _silu(x):
    return torch.nn.functional.silu(x)
def _sigmoid(x):
    return torch.sigmoid(x)
def _layernorm(x, axis=-1, eps=1e-5):
    m = x.mean(dim=axis, keepdim=True)
    v = x.var(dim=axis, keepdim=True, unbiased=False)
    return (x - m) / torch.sqrt(v + eps)
def _scatter_add(tgt, idx, src, axis=0):
    return tgt.clone().index_add_(axis, idx, src)
def _segment_sum(src, seg, n):
    out = torch.zeros((n,) + src.shape[1:], dtype=src.dtype)
    return out.index_add_(0, seg, src)
def _pad(x, pw):
    flat = tuple(v for pair in reversed(pw) for v in pair)
    return torch.nn.functional.pad(x, flat)

kernel_name = 'standalone__sliding_block__prompt'

def setup_inputs():

    _w = (lambda a: (lambda t: t.to(torch.bfloat16) if t.is_floating_point() else t)(torch.as_tensor(a)))
    B, S, D = 1, 2048, 1024
    return {
        "x": _w((lambda *s: torch.randn(*s, dtype=torch.bfloat16) * 0.2)(B, S, D)),
        "wqkv": _w((lambda *s: torch.randn(*s, dtype=torch.bfloat16) * 0.2)(D, 3 * D)),
        "wo": _w((lambda *s: torch.randn(*s, dtype=torch.bfloat16) * 0.05)(D, D)),
    }

def reference(x, wqkv, wo):
    B, S, D = x.shape
    H = 32; Dh = D // H; W = 256
    qkv = (lambda x, *d: x.permute(*d))((x @ wqkv).reshape(B, S, 3, H, Dh), 2, 0, 3, 1, 4)
    q, k, v = qkv[0], qkv[1], qkv[2]
    scores = torch.einsum("bhqd,bhkd->bhqk", q, k) * (Dh ** -0.5)
    idx = torch.arange(S)
    mask = (idx[:, None] - idx[None, :] >= 0) & (idx[:, None] - idx[None, :] < W)
    scores = torch.where(mask[None, None], scores, -1e9)
    p = _softmax(scores, axis=-1)
    o = torch.einsum("bhqk,bhkd->bhqd", p, v)
    return (lambda x, *d: x.permute(*d))(o, 0, 2, 1, 3).reshape(B, S, D) @ wo
```

```asm
; @launch grid=(256,1,1) block=(512,1,1) lds=163840
.amdgcn_target "amdgcn-amd-amdhsa--gfx950"
.text
.globl standalone__sliding_block__prompt_kernel
.p2align 8
.type standalone__sliding_block__prompt_kernel,@function
standalone__sliding_block__prompt_kernel:
    s_cmp_ge_u32 s2, 256
    s_cbranch_scc1 L_end
    s_load_dwordx8 s[4:11], s[0:1], 0
    s_load_dwordx4 s[12:15], s[0:1], 32
    s_getpc_b64 s[70:71]
    v_lshlrev_b32 v1, 7, v0
    v_cmp_gt_u32 vcc, 6144, v1
    s_and_saveexec_b64 s[72:73], vcc
    s_cbranch_execz L_ecp
    global_load_dword v230, v1, s[70:71]
L_ecp:
    s_mov_b64 exec, s[72:73]
    s_and_b32 s43, s2, 7
    s_lshr_b32 s44, s2, 3
    s_and_b32 s40, s44, 15
    s_lshr_b32 s44, s44, 4
    s_lshl_b32 s41, s43, 1
    s_add_u32 s41, s41, s44
    v_lshrrev_b32 v1, 6, v0
    v_and_b32 v2, 63, v0
    v_readfirstlane_b32 s42, v1
    s_cmp_lt_u32 s42, 4
    s_cbranch_scc1 L_cw
    s_cmp_lg_u32 s42, 4
    s_cbranch_scc1 L_nx
    v_lshrrev_b32 v3, 3, v2
    v_and_b32 v4, 7, v2
    v_lshrrev_b32 v5, 1, v3
    v_xor_b32 v6, v5, v4
    v_xor_b32 v7, 4, v6
    s_lshl_b32 s44, s40, 7
    v_add_u32 v5, s44, v3
    v_lshlrev_b32 v5, 11, v5
    v_lshl_add_u32 v10, v6, 4, v5
    v_lshl_add_u32 v11, v7, 4, v5
    s_waitcnt lgkmcnt(0)
    s_mov_b32 s16, s4
    s_mov_b32 s17, s5
    s_mov_b32 s18, 0x400000
    s_mov_b32 s19, 0x20000
    s_mov_b32 s49, 0
    s_mov_b32 s47, 0
    s_mov_b32 s50, 0
L_xl_a:
    s_add_u32 m0, s49, 0
    s_add_u32 s48, s47, 0
    buffer_load_dwordx4 v10, s[16:19], s48 offen  lds
    s_add_u32 m0, s49, 1024
    s_add_u32 s48, s47, 16384
    buffer_load_dwordx4 v11, s[16:19], s48 offen  lds
    s_add_u32 m0, s49, 2048
    s_add_u32 s48, s47, 32768
    buffer_load_dwordx4 v10, s[16:19], s48 offen  lds
    s_add_u32 m0, s49, 3072
    s_add_u32 s48, s47, 49152
    buffer_load_dwordx4 v11, s[16:19], s48 offen  lds
    s_add_u32 m0, s49, 4096
    s_add_u32 s48, s47, 65536
    buffer_load_dwordx4 v10, s[16:19], s48 offen  lds
    s_add_u32 m0, s49, 5120
    s_add_u32 s48, s47, 81920
    buffer_load_dwordx4 v11, s[16:19], s48 offen  lds
    s_add_u32 m0, s49, 6144
    s_add_u32 s48, s47, 98304
    buffer_load_dwordx4 v10, s[16:19], s48 offen  lds
    s_add_u32 m0, s49, 7168
    s_add_u32 s48, s47, 114688
    buffer_load_dwordx4 v11, s[16:19], s48 offen  lds
    s_add_u32 m0, s49, 8192
    s_add_u32 s48, s47, 131072
    buffer_load_dwordx4 v10, s[16:19], s48 offen  lds
    s_add_u32 m0, s49, 9216
    s_add_u32 s48, s47, 147456
    buffer_load_dwordx4 v11, s[16:19], s48 offen  lds
    s_add_u32 m0, s49, 10240
    s_add_u32 s48, s47, 163840
    buffer_load_dwordx4 v10, s[16:19], s48 offen  lds
    s_add_u32 m0, s49, 11264
    s_add_u32 s48, s47, 180224
    buffer_load_dwordx4 v11, s[16:19], s48 offen  lds
    s_add_u32 m0, s49, 12288
    s_add_u32 s48, s47, 196608
    buffer_load_dwordx4 v10, s[16:19], s48 offen  lds
    s_add_u32 m0, s49, 13312
    s_add_u32 s48, s47, 212992
    buffer_load_dwordx4 v11, s[16:19], s48 offen  lds
    s_add_u32 m0, s49, 14336
    s_add_u32 s48, s47, 229376
    buffer_load_dwordx4 v10, s[16:19], s48 offen  lds
    s_add_u32 m0, s49, 15360
    s_add_u32 s48, s47, 245760
    buffer_load_dwordx4 v11, s[16:19], s48 offen  lds
    s_add_u32 s47, s47, 128
    s_add_u32 s49, s49, 40960
    s_cmp_ge_u32 s49, 163840
    s_cselect_b32 s49, 0, s49
    s_add_u32 s50, s50, 1
    s_cmp_eq_u32 s50, 1
    s_cbranch_scc1 L_xl_a
    s_cmp_eq_u32 s50, 10
    s_cbranch_scc1 L_xl_a
    s_cmp_gt_u32 s50, 10
    s_cbranch_scc1 L_xl_b
    s_waitcnt vmcnt(16)
    s_barrier
    s_branch L_xl_a
L_xl_b:
    s_waitcnt vmcnt(32)
    s_barrier
    s_cmp_lt_u32 s50, 16
    s_cbranch_scc1 L_xl_a
    s_waitcnt vmcnt(16)
    s_barrier
    s_waitcnt vmcnt(0)
    s_branch L_ld_tail
L_nx:
    s_cmp_eq_u32 s42, 7
    s_cbranch_scc1 L_aux
    v_lshrrev_b32 v3, 3, v2
    v_and_b32 v4, 7, v2
    v_and_b32 v5, 2, v3
    v_xor_b32 v6, v5, v4
    v_xor_b32 v7, 4, v6
    s_sub_u32 s43, s42, 5
    s_lshl_b32 s44, s43, 5
    v_add_u32 v5, s44, v3
    v_mul_u32_u24 v5, 0x1800, v5
    s_lshl_b32 s44, s41, 7
    v_add_u32 v5, s44, v5
    v_lshl_add_u32 v10, v6, 4, v5
    v_lshl_add_u32 v11, v7, 4, v5
    s_lshl_b32 s46, s43, 12
    s_add_u32 s46, s46, 0x4000
    s_waitcnt lgkmcnt(0)
    s_mov_b32 s20, s6
    s_mov_b32 s21, s7
    s_mov_b32 s22, 0x600000
    s_mov_b32 s23, 0x20000
    s_mov_b32 s49, s46
    s_mov_b32 s47, 0
    s_mov_b32 s50, 0
L_wl_a:
    s_add_u32 m0, s49, 16384
    s_add_u32 s48, s47, 4096
    buffer_load_dwordx4 v10, s[20:23], s48 offen nt lds
    s_add_u32 m0, s49, 17408
    s_add_u32 s48, s47, 53248
    buffer_load_dwordx4 v11, s[20:23], s48 offen nt lds
    s_add_u32 m0, s49, 18432
    s_add_u32 s48, s47, 102400
    buffer_load_dwordx4 v10, s[20:23], s48 offen nt lds
    s_add_u32 m0, s49, 19456
    s_add_u32 s48, s47, 151552
    buffer_load_dwordx4 v11, s[20:23], s48 offen nt lds
    s_add_u32 m0, s49, 8192
    s_add_u32 s48, s47, 2048
    buffer_load_dwordx4 v10, s[20:23], s48 offen nt lds
    s_add_u32 m0, s49, 9216
    s_add_u32 s48, s47, 51200
    buffer_load_dwordx4 v11, s[20:23], s48 offen nt lds
    s_add_u32 m0, s49, 10240
    s_add_u32 s48, s47, 100352
    buffer_load_dwordx4 v10, s[20:23], s48 offen nt lds
    s_add_u32 m0, s49, 11264
    s_add_u32 s48, s47, 149504
    buffer_load_dwordx4 v11, s[20:23], s48 offen nt lds
    s_add_u32 m0, s49, 0
    s_add_u32 s48, s47, 0
    buffer_load_dwordx4 v10, s[20:23], s48 offen nt lds
    s_add_u32 m0, s49, 1024
    s_add_u32 s48, s47, 49152
    buffer_load_dwordx4 v11, s[20:23], s48 offen nt lds
    s_add_u32 m0, s49, 2048
    s_add_u32 s48, s47, 98304
    buffer_load_dwordx4 v10, s[20:23], s48 offen nt lds
    s_add_u32 m0, s49, 3072
    s_add_u32 s48, s47, 147456
    buffer_load_dwordx4 v11, s[20:23], s48 offen nt lds
    s_add_u32 s47, s47, 393216
    s_add_u32 s49, s49, 40960
    s_cmp_ge_u32 s49, 163840
    s_cselect_b32 s49, s46, s49
    s_add_u32 s50, s50, 1
    s_cmp_eq_u32 s50, 1
    s_cbranch_scc1 L_wl_a
    s_cmp_eq_u32 s50, 10
    s_cbranch_scc1 L_wl_a
    s_cmp_gt_u32 s50, 10
    s_cbranch_scc1 L_wl_b
    s_waitcnt vmcnt(12)
    s_barrier
    s_branch L_wl_a
L_wl_b:
    s_waitcnt vmcnt(24)
    s_barrier
    s_cmp_lt_u32 s50, 16
    s_cbranch_scc1 L_wl_a
    s_waitcnt vmcnt(12)
    s_barrier
    s_waitcnt vmcnt(0)
    s_branch L_ld_tail
L_aux:
    s_lshl_b32 s55, s2, 3
    v_and_b32 v5, 7, v2
    v_add_u32 v5, s55, v5
    v_lshlrev_b32 v5, 11, v5
    v_lshrrev_b32 v6, 3, v2
    v_lshl_add_u32 v20, v6, 7, v5
    s_lshr_b32 s52, s2, 3
    s_and_b32 s53, s2, 7
    v_lshrrev_b32 v5, 4, v2
    v_lshlrev_b32 v5, 6, v5
    v_bfe_u32 v6, v2, 3, 1
    v_add_u32 v5, v5, v6
    s_lshl_b32 s55, s52, 1
    v_add_u32 v5, s55, v5
    v_mul_u32_u24 v5, 0x1800, v5
    v_bfe_u32 v6, v2, 1, 2
    v_lshl_add_u32 v5, v6, 11, v5
    v_and_b32 v7, 1, v2
    v_lshl_add_u32 v5, v7, 7, v5
    s_lshl_b32 s55, s53, 8
    v_add_u32 v21, s55, v5
    v_mov_b32 v7, 0x7fffffff
    v_cmp_eq_u32 vcc, 3, v6
    s_nop 1
    v_cndmask_b32 v21, v21, v7, vcc
    v_cmp_le_u32 vcc, 32, v2
    s_nop 1
    v_cndmask_b32 v20, v20, v7, vcc
    v_lshlrev_b32 v22, 7, v2
    v_lshrrev_b32 v3, 3, v2
    v_and_b32 v4, 7, v2
    v_and_b32 v5, 6, v3
    v_xor_b32 v4, v4, v5
    v_lshlrev_b32 v3, 11, v3
    v_lshl_add_u32 v3, v4, 4, v3
    s_lshl_b32 s44, s40, 7
    v_add_u32 v12, s44, v3
    s_memrealtime s[60:61]
    s_waitcnt lgkmcnt(0)
    s_mov_b32 s16, s4
    s_mov_b32 s17, s5
    s_mov_b32 s18, 0x400000
    s_mov_b32 s19, 0x20000
    s_mov_b32 s20, s6
    s_mov_b32 s21, s7
    s_mov_b32 s22, 0x600000
    s_mov_b32 s23, 0x20000
    s_mov_b32 s24, s8
    s_mov_b32 s25, s9
    s_mov_b32 s26, 0x200000
    s_mov_b32 s27, 0x20000
    s_mov_b32 s28, s10
    s_mov_b32 s29, s11
    s_mov_b32 s30, 0x400000
    s_mov_b32 s31, 0x20000
    s_mov_b32 s32, s14
    s_mov_b32 s33, s15
    s_mov_b32 s34, 0x10000000
    s_mov_b32 s35, 0x20000
    s_mov_b32 s36, s12
    s_mov_b32 s37, s13
    s_mov_b32 s38, 0x100
    s_mov_b32 s39, 0x20000
    s_andn2_b32 s60, s60, 15
    s_or_b32 s60, s60, 16
    v_mov_b32 v24, s60
    v_mov_b32 v25, s61
    v_mov_b32 v26, 0
    v_mov_b32 v27, 0
    v_mov_b32 v8, 0
    s_mov_b32 s57, 256
    s_mov_b32 s58, 786432
    buffer_load_dword v30, v21, s[20:23], s58 offen
    buffer_load_dword v31, v20, s[16:19], s57 offen
    s_mov_b32 s57, 768
    s_mov_b32 s58, 2359296
    s_mov_b32 exec_lo, 0xffff
    s_mov_b32 exec_hi, 0x0
    buffer_load_dword v30, v21, s[20:23], s58 offen
    s_mov_b64 exec, 0xff
    buffer_load_dword v31, v20, s[16:19], s57 offen
    s_mov_b64 exec, -1
    s_cmp_lg_u32 s2, 0
    s_cbranch_scc1 L_nn
    s_mov_b64 exec, 1
    buffer_store_dwordx2 v[24:25], v8, s[36:39], 0 offen sc1
    s_mov_b64 exec, -1
L_nn:
    s_barrier
    s_barrier
    s_barrier
    s_mov_b32 s57, 896
    s_mov_b32 s58, 2752512
    buffer_load_dword v30, v21, s[20:23], s58 offen
    buffer_load_dword v31, v20, s[16:19], s57 offen
    s_mov_b32 s57, 1408
    s_mov_b32 s58, 4325376
    s_mov_b32 exec_lo, 0xffff
    s_mov_b32 exec_hi, 0x0
    buffer_load_dword v30, v21, s[20:23], s58 offen
    s_mov_b64 exec, 0xff
    buffer_load_dword v31, v20, s[16:19], s57 offen
    s_mov_b64 exec, -1
    v_and_b32 v1, 31, v2
    v_lshrrev_b32 v5, 5, v2
    v_lshlrev_b32 v5, 2, v5
    v_sub_u32 v1, v1, v5
    v_cvt_f32_i32 v1, v1
    v_mul_f32 v1, 0x7149f2ca, v1
    v_sub_f32 v240, 0xf0c9f2ca, v1
    v_sub_f32 v241, 0x70c9f2ca, v1
    v_sub_f32 v242, 0x71977617, v1
    v_sub_f32 v243, 0x71fc6f7c, v1
    v_sub_f32 v244, 0x72bd539d, v1
    v_sub_f32 v245, 0x72d691f6, v1
    v_sub_f32 v246, 0x72efd050, v1
    v_sub_f32 v247, 0x73048754, v1
    v_sub_f32 v248, 0x7343a333, v1
    v_sub_f32 v249, 0x73504260, v1
    v_sub_f32 v250, 0x735ce18d, v1
    v_sub_f32 v251, 0x736980b9, v1
    v_sub_f32 v252, 0x73944e4c, v1
    v_sub_f32 v253, 0x739a9de3, v1
    v_sub_f32 v254, 0x73a0ed79, v1
    v_sub_f32 v255, 0x73a73d0f, v1
    v_min_f32 v240, 0, v240
    v_min_f32 v241, 0, v241
    v_min_f32 v242, 0, v242
    v_min_f32 v243, 0, v243
    v_min_f32 v244, 0, v244
    v_min_f32 v245, 0, v245
    v_min_f32 v246, 0, v246
    v_min_f32 v247, 0, v247
    v_min_f32 v248, 0, v248
    v_min_f32 v249, 0, v249
    v_min_f32 v250, 0, v250
    v_min_f32 v251, 0, v251
    v_min_f32 v252, 0, v252
    v_min_f32 v253, 0, v253
    v_min_f32 v254, 0, v254
    v_min_f32 v255, 0, v255
    s_barrier
    s_barrier
    s_barrier
    s_barrier
    s_mov_b32 s57, 1536
    s_mov_b32 s58, 4718592
    buffer_load_dword v30, v21, s[20:23], s58 offen
    buffer_load_dword v31, v20, s[16:19], s57 offen
    s_getpc_b64 s[70:71]
Lpc_1:
    s_sub_u32 s70, s70, Lpc_1-standalone__sliding_block__prompt_kernel
    s_subb_u32 s71, s71, 0
    s_lshr_b32 s57, s2, 3
    s_lshl_b32 s57, s57, 11
    v_and_b32 v5, 15, v2
    v_lshlrev_b32 v5, 7, v5
    v_add_u32 v5, s57, v5
    v_mov_b32 v6, L_code_end-standalone__sliding_block__prompt_kernel-4
    v_min_u32 v5, v5, v6
    global_load_dword v30, v5, s[70:71]
    buffer_load_dwordx2 v[24:25], v8, s[36:39], 0 offen sc1
    s_barrier
    s_barrier
    s_barrier
    s_barrier
    s_mov_b32 s54, 0
    s_branch L_nchk
L_nre:
    buffer_load_dwordx2 v[24:25], v8, s[36:39], 0 offen sc1
L_nchk:
    s_waitcnt vmcnt(0)
    v_readfirstlane_b32 s60, v24
    v_readfirstlane_b32 s61, v25
    s_add_u32 s54, s54, 1
    s_cmp_gt_u32 s54, 400000
    s_cbranch_scc1 L_nok
    s_cmp_eq_u32 s60, 0
    s_cbranch_scc1 L_nre
L_nok:
    s_barrier
    s_barrier
    s_barrier
    s_lshl_b32 s57, s2, 13
    buffer_load_dword v30, v22, s[24:27], s57 offen
    v_lshlrev_b32 v5, 6, v2
    s_lshl_b32 s57, s41, 12
    s_add_u32 s57, s57, 13631488
    buffer_load_dword v30, v5, s[32:35], s57 offen
    v_and_b32 v5, 1, v2
    v_bfe_u32 v6, v2, 1, 1
    v_lshl_add_u32 v5, v6, 5, v5
    v_lshlrev_b32 v5, 7, v5
    s_lshl_b32 s57, s41, 6
    s_lshl_b32 s58, s40, 1
    s_add_u32 s57, s57, s58
    s_lshl_b32 s57, s57, 7
    s_add_u32 s57, s57, 12845056
    buffer_load_dword v30, v5, s[32:35], s57 offen
    s_barrier
    v_mov_b32 v5, 24576
    ds_write_b64 v5, v[24:25]
    s_waitcnt lgkmcnt(0)
    s_barrier
    s_barrier
    v_lshlrev_b32 v3, 4, v2
    ds_write_b128 v3, v[240:243] offset:18432
    ds_write_b128 v3, v[244:247] offset:19456
    ds_write_b128 v3, v[248:251] offset:20480
    ds_write_b128 v3, v[252:255] offset:21504
    s_branch L_ht
L_cw:
    s_and_b32 s44, s42, 1
    s_lshr_b32 s45, s42, 1
    v_and_b32 v3, 15, v2
    v_lshrrev_b32 v4, 4, v2
    v_lshrrev_b32 v5, 1, v3
    s_lshl_b32 s46, s45, 6
    v_add_u32 v6, s46, v3
    v_lshlrev_b32 v6, 7, v6
    v_add_u32 v7, 0, v4
    v_xor_b32 v7, v7, v5
    v_lshl_add_u32 v192, v7, 4, v6
    v_add_u32 v7, 4, v4
    v_xor_b32 v7, v7, v5
    v_lshl_add_u32 v193, v7, 4, v6
    v_bfe_u32 v5, v2, 2, 2
    v_and_b32 v6, 3, v2
    v_lshl_add_u32 v7, v4, 3, v5
    v_lshrrev_b32 v8, 1, v5
    v_and_b32 v9, 1, v4
    v_lshl_or_b32 v8, v9, 1, v8
    s_lshl_b32 s46, s44, 1
    v_xor_b32 v8, s46, v8
    v_lshlrev_b32 v7, 7, v7
    v_lshl_add_u32 v7, v8, 5, v7
    v_lshl_add_u32 v7, v6, 3, v7
    v_add_u32 v194, 0x4000, v7
    v_xor_b32 v195, 32, v194
    v_mov_b32 v16, 0
    v_mov_b32 v17, 0
    v_mov_b32 v18, 0
    v_mov_b32 v19, 0
    v_mov_b32 v20, 0
    v_mov_b32 v21, 0
    v_mov_b32 v22, 0
    v_mov_b32 v23, 0
    v_mov_b32 v24, 0
    v_mov_b32 v25, 0
    v_mov_b32 v26, 0
    v_mov_b32 v27, 0
    v_mov_b32 v28, 0
    v_mov_b32 v29, 0
    v_mov_b32 v30, 0
    v_mov_b32 v31, 0
    v_mov_b32 v32, 0
    v_mov_b32 v33, 0
    v_mov_b32 v34, 0
    v_mov_b32 v35, 0
    v_mov_b32 v36, 0
    v_mov_b32 v37, 0
    v_mov_b32 v38, 0
    v_mov_b32 v39, 0
    v_mov_b32 v40, 0
    v_mov_b32 v41, 0
    v_mov_b32 v42, 0
    v_mov_b32 v43, 0
    v_mov_b32 v44, 0
    v_mov_b32 v45, 0
    v_mov_b32 v46, 0
    v_mov_b32 v47, 0
    v_mov_b32 v48, 0
    v_mov_b32 v49, 0
    v_mov_b32 v50, 0
    v_mov_b32 v51, 0
    v_mov_b32 v52, 0
    v_mov_b32 v53, 0
    v_mov_b32 v54, 0
    v_mov_b32 v55, 0
    v_mov_b32 v56, 0
    v_mov_b32 v57, 0
    v_mov_b32 v58, 0
    v_mov_b32 v59, 0
    v_mov_b32 v60, 0
    v_mov_b32 v61, 0
    v_mov_b32 v62, 0
    v_mov_b32 v63, 0
    v_mov_b32 v64, 0
    v_mov_b32 v65, 0
    v_mov_b32 v66, 0
    v_mov_b32 v67, 0
    v_mov_b32 v68, 0
    v_mov_b32 v69, 0
    v_mov_b32 v70, 0
    v_mov_b32 v71, 0
    v_mov_b32 v72, 0
    v_mov_b32 v73, 0
    v_mov_b32 v74, 0
    v_mov_b32 v75, 0
    v_mov_b32 v76, 0
    v_mov_b32 v77, 0
    v_mov_b32 v78, 0
    v_mov_b32 v79, 0
    v_mov_b32 v80, 0
    v_mov_b32 v81, 0
    v_mov_b32 v82, 0
    v_mov_b32 v83, 0
    v_mov_b32 v84, 0
    v_mov_b32 v85, 0
    v_mov_b32 v86, 0
    v_mov_b32 v87, 0
    v_mov_b32 v88, 0
    v_mov_b32 v89, 0
    v_mov_b32 v90, 0
    v_mov_b32 v91, 0
    v_mov_b32 v92, 0
    v_mov_b32 v93, 0
    v_mov_b32 v94, 0
    v_mov_b32 v95, 0
    v_mov_b32 v96, 0
    v_mov_b32 v97, 0
    v_mov_b32 v98, 0
    v_mov_b32 v99, 0
    v_mov_b32 v100, 0
    v_mov_b32 v101, 0
    v_mov_b32 v102, 0
    v_mov_b32 v103, 0
    v_mov_b32 v104, 0
    v_mov_b32 v105, 0
    v_mov_b32 v106, 0
    v_mov_b32 v107, 0
    v_mov_b32 v108, 0
    v_mov_b32 v109, 0
    v_mov_b32 v110, 0
    v_mov_b32 v111, 0
    v_mov_b32 v152, 0
    v_mov_b32 v153, 0
    v_mov_b32 v154, 0
    v_mov_b32 v155, 0
    v_mov_b32 v156, 0
    v_mov_b32 v157, 0
    v_mov_b32 v158, 0
    v_mov_b32 v159, 0
    v_mov_b32 v160, 0
    v_mov_b32 v161, 0
    v_mov_b32 v162, 0
    v_mov_b32 v163, 0
    v_mov_b32 v164, 0
    v_mov_b32 v165, 0
    v_mov_b32 v166, 0
    v_mov_b32 v167, 0
    v_mov_b32 v168, 0
    v_mov_b32 v169, 0
    v_mov_b32 v170, 0
    v_mov_b32 v171, 0
    v_mov_b32 v172, 0
    v_mov_b32 v173, 0
    v_mov_b32 v174, 0
    v_mov_b32 v175, 0
    v_mov_b32 v176, 0
    v_mov_b32 v177, 0
    v_mov_b32 v178, 0
    v_mov_b32 v179, 0
    v_mov_b32 v180, 0
    v_mov_b32 v181, 0
    v_mov_b32 v182, 0
    v_mov_b32 v183, 0
    v_mov_b32 v184, 0
    v_mov_b32 v185, 0
    v_mov_b32 v186, 0
    v_mov_b32 v187, 0
    v_mov_b32 v188, 0
    v_mov_b32 v189, 0
    v_mov_b32 v190, 0
    v_mov_b32 v191, 0
    v_mov_b32 v196, v192
    v_mov_b32 v197, v193
    v_mov_b32 v198, v194
    v_mov_b32 v199, v195
    s_lshl_b32 s62, s41, 1
    s_add_u32 s62, s62, s44
    s_lshl_b32 s47, s40, 1
    s_add_u32 s47, s47, s45
    s_lshl_b32 s48, s62, 5
    s_add_u32 s48, s48, s47
    s_lshl_b32 s65, s48, 7
    s_add_u32 s65, s65, 12582912
    s_lshl_b32 s64, s48, 13
    s_add_u32 s49, s64, 4096
    s_lshl_b32 s66, s40, 7
    s_add_u32 s66, s66, s62
    s_lshl_b32 s67, s66, 5
    s_add_u32 s67, s67, 13631488
    s_lshl_b32 s66, s66, 11
    s_add_u32 s66, s66, 8388608
    s_mov_b32 s63, 0
    s_mov_b32 s74, 0
    s_mov_b32 s76, -1
    v_lshlrev_b32 v3, 4, v2
    v_lshrrev_b32 v1, 4, v2
    v_xor_b32 v1, v1, v2
    v_and_b32 v1, 1, v1
    v_add_u32 v1, -1, v1
    v_and_b32 v1, 0x3f803f80, v1
    v_mov_b32 v4, v1
    v_mov_b32 v5, v1
    v_mov_b32 v6, v1
    v_mov_b32 v7, v1
    s_cmp_ge_u32 s40, 1
    s_cselect_b32 s56, -1, 0
    s_cselect_b32 s52, 0, 0x40000000
    s_cmp_ge_u32 s40, 2
    s_cselect_b32 s57, -1, 0
    s_cselect_b32 s53, 0, 0x40000000
    v_and_b32 v8, s56, v1
    v_and_b32 v9, s56, v1
    v_and_b32 v10, s56, v1
    v_and_b32 v11, s56, v1
    v_and_b32 v12, s57, v1
    v_and_b32 v13, s57, v1
    v_and_b32 v14, s57, v1
    v_and_b32 v15, s57, v1
    s_add_u32 s68, s52, s64
    s_sub_u32 s68, s68, 0x4000
    s_add_u32 s69, s53, s64
    s_sub_u32 s69, s69, 0x8000
    v_and_b32 v1, 31, v2
    v_lshrrev_b32 v0, 5, v2
    v_lshlrev_b32 v0, 2, v0
    v_sub_u32 v1, v1, v0
    v_cvt_f32_i32 v1, v1
    v_mul_f32 v1, 0x7149f2ca, v1
    v_add_f32 v240, 0x70c9f2ca, v1
    v_add_f32 v241, 0xf0c9f2ca, v1
    v_add_f32 v242, 0xf1977617, v1
    v_add_f32 v243, 0xf1fc6f7c, v1
    v_add_f32 v244, 0xf2bd539d, v1
    v_add_f32 v245, 0xf2d691f6, v1
    v_add_f32 v246, 0xf2efd050, v1
    v_add_f32 v247, 0xf3048754, v1
    v_add_f32 v248, 0xf343a333, v1
    v_add_f32 v249, 0xf3504260, v1
    v_add_f32 v250, 0xf35ce18d, v1
    v_add_f32 v251, 0xf36980b9, v1
    v_add_f32 v252, 0xf3944e4c, v1
    v_add_f32 v253, 0xf39a9de3, v1
    v_add_f32 v254, 0xf3a0ed79, v1
    v_add_f32 v255, 0xf3a73d0f, v1
    v_min_f32 v240, 0, v240
    v_min_f32 v241, 0, v241
    v_min_f32 v242, 0, v242
    v_min_f32 v243, 0, v243
    v_min_f32 v244, 0, v244
    v_min_f32 v245, 0, v245
    v_min_f32 v246, 0, v246
    v_min_f32 v247, 0, v247
    v_min_f32 v248, 0, v248
    v_min_f32 v249, 0, v249
    v_min_f32 v250, 0, v250
    v_min_f32 v251, 0, v251
    v_min_f32 v252, 0, v252
    v_min_f32 v253, 0, v253
    v_min_f32 v254, 0, v254
    v_min_f32 v255, 0, v255
    s_lshl_b32 s58, s44, 2
    v_mov_b32 v0, s58
    s_waitcnt lgkmcnt(0)
    s_mov_b32 s28, s10
    s_mov_b32 s29, s11
    s_mov_b32 s30, 0x400000
    s_mov_b32 s31, 0x20000
    s_mov_b32 s32, s14
    s_mov_b32 s33, s15
    s_mov_b32 s34, 0x10000000
    s_mov_b32 s35, 0x20000
    s_mov_b32 s47, 0
    s_mov_b32 s50, 12
Lmm_2:
    s_waitcnt lgkmcnt(0)
    v_mfma_f32_16x16x32_bf16 v[16:19], v[168:171], v[152:155], v[16:19]
    v_mfma_f32_16x16x32_bf16 v[20:23], v[168:171], v[156:159], v[20:23]
    v_mfma_f32_16x16x32_bf16 v[24:27], v[168:171], v[160:163], v[24:27]
    v_mfma_f32_16x16x32_bf16 v[28:31], v[168:171], v[164:167], v[28:31]
    s_barrier
    v_mfma_f32_16x16x32_bf16 v[32:35], v[172:175], v[152:155], v[32:35]
    ds_read_b128 v[112:115], v196 offset:0
    v_mfma_f32_16x16x32_bf16 v[36:39], v[172:175], v[156:159], v[36:39]
    ds_read_b64_tr_b16 v[128:129], v198 offset:0
    v_mfma_f32_16x16x32_bf16 v[40:43], v[172:175], v[160:163], v[40:43]
    ds_read_b64_tr_b16 v[130:131], v198 offset:512
    v_mfma_f32_16x16x32_bf16 v[44:47], v[172:175], v[164:167], v[44:47]
    ds_read_b128 v[116:119], v196 offset:2048
    v_mfma_f32_16x16x32_bf16 v[48:51], v[176:179], v[152:155], v[48:51]
    ds_read_b128 v[120:123], v196 offset:4096
    v_mfma_f32_16x16x32_bf16 v[52:55], v[176:179], v[156:159], v[52:55]
    ds_read_b128 v[124:127], v196 offset:6144
    v_mfma_f32_16x16x32_bf16 v[56:59], v[176:179], v[160:163], v[56:59]
    ds_read_b64_tr_b16 v[132:133], v199 offset:0
    v_mfma_f32_16x16x32_bf16 v[60:63], v[176:179], v[164:167], v[60:63]
    ds_read_b64_tr_b16 v[134:135], v199 offset:512
    v_mfma_f32_16x16x32_bf16 v[64:67], v[180:183], v[152:155], v[64:67]
    ds_read_b64_tr_b16 v[136:137], v198 offset:8192
    v_mfma_f32_16x16x32_bf16 v[68:71], v[180:183], v[156:159], v[68:71]
    ds_read_b64_tr_b16 v[138:139], v198 offset:8704
    v_mfma_f32_16x16x32_bf16 v[72:75], v[180:183], v[160:163], v[72:75]
    ds_read_b64_tr_b16 v[140:141], v199 offset:8192
    v_mfma_f32_16x16x32_bf16 v[76:79], v[180:183], v[164:167], v[76:79]
    ds_read_b64_tr_b16 v[142:143], v199 offset:8704
    v_mfma_f32_16x16x32_bf16 v[80:83], v[152:155], v[184:187], v[80:83]
    ds_read_b64_tr_b16 v[144:145], v198 offset:16384
    v_mfma_f32_16x16x32_bf16 v[84:87], v[156:159], v[184:187], v[84:87]
    ds_read_b64_tr_b16 v[146:147], v198 offset:16896
    v_mfma_f32_16x16x32_bf16 v[88:91], v[160:163], v[184:187], v[88:91]
    ds_read_b64_tr_b16 v[148:149], v199 offset:16384
    v_mfma_f32_16x16x32_bf16 v[92:95], v[164:167], v[184:187], v[92:95]
    ds_read_b64_tr_b16 v[150:151], v199 offset:16896
    v_mfma_f32_16x16x32_bf16 v[96:99], v[152:155], v[188:191], v[96:99]
    v_mfma_f32_16x16x32_bf16 v[100:103], v[156:159], v[188:191], v[100:103]
    v_mfma_f32_16x16x32_bf16 v[104:107], v[160:163], v[188:191], v[104:107]
    v_mfma_f32_16x16x32_bf16 v[108:111], v[164:167], v[188:191], v[108:111]
    s_waitcnt lgkmcnt(13)
    v_mfma_f32_16x16x32_bf16 v[16:19], v[128:131], v[112:115], v[16:19]
    ds_read_b128 v[152:155], v197 offset:0
    s_waitcnt lgkmcnt(13)
    v_mfma_f32_16x16x32_bf16 v[20:23], v[128:131], v[116:119], v[20:23]
    ds_read_b64_tr_b16 v[168:169], v198 offset:4096
    s_waitcnt lgkmcnt(13)
    v_mfma_f32_16x16x32_bf16 v[24:27], v[128:131], v[120:123], v[24:27]
    ds_read_b64_tr_b16 v[170:171], v198 offset:4608
    s_waitcnt lgkmcnt(13)
    v_mfma_f32_16x16x32_bf16 v[28:31], v[128:131], v[124:127], v[28:31]
    ds_read_b128 v[156:159], v197 offset:2048
    s_waitcnt lgkmcnt(12)
    v_mfma_f32_16x16x32_bf16 v[32:35], v[132:135], v[112:115], v[32:35]
    ds_read_b128 v[160:163], v197 offset:4096
    v_mfma_f32_16x16x32_bf16 v[36:39], v[132:135], v[116:119], v[36:39]
    ds_read_b128 v[164:167], v197 offset:6144
    v_mfma_f32_16x16x32_bf16 v[40:43], v[132:135], v[120:123], v[40:43]
    ds_read_b64_tr_b16 v[172:173], v199 offset:4096
    v_mfma_f32_16x16x32_bf16 v[44:47], v[132:135], v[124:127], v[44:47]
    ds_read_b64_tr_b16 v[174:175], v199 offset:4608
    s_waitcnt lgkmcnt(14)
    v_mfma_f32_16x16x32_bf16 v[48:51], v[136:139], v[112:115], v[48:51]
    ds_read_b64_tr_b16 v[176:177], v198 offset:12288
    v_mfma_f32_16x16x32_bf16 v[52:55], v[136:139], v[116:119], v[52:55]
    ds_read_b64_tr_b16 v[178:179], v198 offset:12800
    v_mfma_f32_16x16x32_bf16 v[56:59], v[136:139], v[120:123], v[56:59]
    ds_read_b64_tr_b16 v[180:181], v199 offset:12288
    v_mfma_f32_16x16x32_bf16 v[60:63], v[136:139], v[124:127], v[60:63]
    ds_read_b64_tr_b16 v[182:183], v199 offset:12800
    s_waitcnt lgkmcnt(15)
    v_mfma_f32_16x16x32_bf16 v[64:67], v[140:143], v[112:115], v[64:67]
    ds_read_b64_tr_b16 v[184:185], v198 offset:20480
    v_mfma_f32_16x16x32_bf16 v[68:71], v[140:143], v[116:119], v[68:71]
    ds_read_b64_tr_b16 v[186:187], v198 offset:20992
    v_mfma_f32_16x16x32_bf16 v[72:75], v[140:143], v[120:123], v[72:75]
    ds_read_b64_tr_b16 v[188:189], v199 offset:20480
    v_mfma_f32_16x16x32_bf16 v[76:79], v[140:143], v[124:127], v[76:79]
    ds_read_b64_tr_b16 v[190:191], v199 offset:20992
    s_waitcnt lgkmcnt(15)
    v_mfma_f32_16x16x32_bf16 v[80:83], v[112:115], v[144:147], v[80:83]
    v_mfma_f32_16x16x32_bf16 v[84:87], v[116:119], v[144:147], v[84:87]
    v_mfma_f32_16x16x32_bf16 v[88:91], v[120:123], v[144:147], v[88:91]
    s_add_u32 s47, s47, 40960
    s_cmp_ge_u32 s47, 163840
    s_cselect_b32 s47, 0, s47
    v_mfma_f32_16x16x32_bf16 v[92:95], v[124:127], v[144:147], v[92:95]
    v_add_u32 v196, s47, v192
    v_mfma_f32_16x16x32_bf16 v[96:99], v[112:115], v[148:151], v[96:99]
    v_add_u32 v197, s47, v193
    v_mfma_f32_16x16x32_bf16 v[100:103], v[116:119], v[148:151], v[100:103]
    v_add_u32 v198, s47, v194
    v_mfma_f32_16x16x32_bf16 v[104:107], v[120:123], v[148:151], v[104:107]
    v_add_u32 v199, s47, v195
    v_mfma_f32_16x16x32_bf16 v[108:111], v[124:127], v[148:151], v[108:111]
    s_sub_u32 s50, s50, 1
    s_cmp_lg_u32 s50, 0
    s_cbranch_scc1 Lmm_2
    s_waitcnt vmcnt(0) lgkmcnt(0)
    v_mfma_f32_16x16x32_bf16 v[16:19], v[168:171], v[152:155], v[16:19]
    v_mfma_f32_16x16x32_bf16 v[20:23], v[168:171], v[156:159], v[20:23]
    v_mfma_f32_16x16x32_bf16 v[24:27], v[168:171], v[160:163], v[24:27]
    v_mfma_f32_16x16x32_bf16 v[28:31], v[168:171], v[164:167], v[28:31]
    s_barrier
    v_mfma_f32_16x16x32_bf16 v[32:35], v[172:175], v[152:155], v[32:35]
    ds_read_b128 v[112:115], v192 offset:0
    v_mfma_f32_16x16x32_bf16 v[36:39], v[172:175], v[156:159], v[36:39]
    ds_read_b64_tr_b16 v[136:137], v194 offset:8192
    v_mfma_f32_16x16x32_bf16 v[40:43], v[172:175], v[160:163], v[40:43]
    v_add_u32 v196, 40960, v192
    ds_read_b64_tr_b16 v[138:139], v194 offset:8704
    v_mfma_f32_16x16x32_bf16 v[44:47], v[172:175], v[164:167], v[44:47]
    v_add_u32 v197, 40960, v193
    ds_read_b128 v[116:119], v192 offset:2048
    v_mfma_f32_16x16x32_bf16 v[48:51], v[176:179], v[152:155], v[48:51]
    v_add_u32 v198, 40960, v194
    ds_read_b128 v[120:123], v192 offset:4096
    v_mfma_f32_16x16x32_bf16 v[52:55], v[176:179], v[156:159], v[52:55]
    v_add_u32 v199, 40960, v195
    ds_read_b128 v[124:127], v192 offset:6144
    v_mfma_f32_16x16x32_bf16 v[56:59], v[176:179], v[160:163], v[56:59]
    v_add_u32 v200, 81920, v192
    ds_read_b64_tr_b16 v[140:141], v195 offset:8192
    v_mfma_f32_16x16x32_bf16 v[60:63], v[176:179], v[164:167], v[60:63]
    v_add_u32 v201, 81920, v193
    ds_read_b64_tr_b16 v[142:143], v195 offset:8704
    v_mfma_f32_16x16x32_bf16 v[64:67], v[180:183], v[152:155], v[64:67]
    v_add_u32 v202, 81920, v194
    ds_read_b64_tr_b16 v[144:145], v194 offset:16384
    v_mfma_f32_16x16x32_bf16 v[68:71], v[180:183], v[156:159], v[68:71]
    v_add_u32 v203, 81920, v195
    ds_read_b64_tr_b16 v[146:147], v194 offset:16896
    v_mfma_f32_16x16x32_bf16 v[72:75], v[180:183], v[160:163], v[72:75]
    v_add_u32 v204, 122880, v192
    ds_read_b64_tr_b16 v[148:149], v195 offset:16384
    v_mfma_f32_16x16x32_bf16 v[76:79], v[180:183], v[164:167], v[76:79]
    v_add_u32 v205, 122880, v193
    ds_read_b64_tr_b16 v[150:151], v195 offset:16896
    v_mfma_f32_16x16x32_bf16 v[80:83], v[152:155], v[184:187], v[80:83]
    v_add_u32 v206, 122880, v194
    v_mfma_f32_16x16x32_bf16 v[84:87], v[156:159], v[184:187], v[84:87]
    v_add_u32 v207, 122880, v195
    v_mfma_f32_16x16x32_bf16 v[88:91], v[160:163], v[184:187], v[88:91]
    v_mfma_f32_16x16x32_bf16 v[92:95], v[164:167], v[184:187], v[92:95]
    v_mfma_f32_16x16x32_bf16 v[96:99], v[152:155], v[188:191], v[96:99]
    v_mfma_f32_16x16x32_bf16 v[100:103], v[156:159], v[188:191], v[100:103]
    v_mfma_f32_16x16x32_bf16 v[104:107], v[160:163], v[188:191], v[104:107]
    v_mfma_f32_16x16x32_bf16 v[108:111], v[164:167], v[188:191], v[108:111]
    s_waitcnt lgkmcnt(9)
    v_mfma_f32_16x16x32_bf16 v[48:51], v[136:139], v[112:115], v[48:51]
    ds_read_b128 v[152:155], v193 offset:0
    s_waitcnt lgkmcnt(9)
    v_mfma_f32_16x16x32_bf16 v[52:55], v[136:139], v[116:119], v[52:55]
    ds_read_b64_tr_b16 v[176:177], v194 offset:12288
    s_waitcnt lgkmcnt(9)
    v_mfma_f32_16x16x32_bf16 v[56:59], v[136:139], v[120:123], v[56:59]
    ds_read_b64_tr_b16 v[178:179], v194 offset:12800
    s_waitcnt lgkmcnt(9)
    v_mfma_f32_16x16x32_bf16 v[60:63], v[136:139], v[124:127], v[60:63]
    ds_read_b128 v[156:159], v193 offset:2048
    s_waitcnt lgkmcnt(8)
    v_mfma_f32_16x16x32_bf16 v[64:67], v[140:143], v[112:115], v[64:67]
    ds_read_b128 v[160:163], v193 offset:4096
    v_mfma_f32_16x16x32_bf16 v[68:71], v[140:143], v[116:119], v[68:71]
    ds_read_b128 v[164:167], v193 offset:6144
    v_mfma_f32_16x16x32_bf16 v[72:75], v[140:143], v[120:123], v[72:75]
    ds_read_b64_tr_b16 v[180:181], v195 offset:12288
    v_mfma_f32_16x16x32_bf16 v[76:79], v[140:143], v[124:127], v[76:79]
    ds_read_b64_tr_b16 v[182:183], v195 offset:12800
    s_waitcnt lgkmcnt(10)
    v_mfma_f32_16x16x32_bf16 v[80:83], v[112:115], v[144:147], v[80:83]
    ds_read_b64_tr_b16 v[184:185], v194 offset:20480
    v_mfma_f32_16x16x32_bf16 v[84:87], v[116:119], v[144:147], v[84:87]
    ds_read_b64_tr_b16 v[186:187], v194 offset:20992
    v_mfma_f32_16x16x32_bf16 v[88:91], v[120:123], v[144:147], v[88:91]
    ds_read_b64_tr_b16 v[188:189], v195 offset:20480
    v_mfma_f32_16x16x32_bf16 v[92:95], v[124:127], v[144:147], v[92:95]
    ds_read_b64_tr_b16 v[190:191], v195 offset:20992
    s_waitcnt lgkmcnt(12)
    v_mfma_f32_16x16x32_bf16 v[96:99], v[112:115], v[148:151], v[96:99]
    v_mfma_f32_16x16x32_bf16 v[100:103], v[116:119], v[148:151], v[100:103]
    v_mfma_f32_16x16x32_bf16 v[104:107], v[120:123], v[148:151], v[104:107]
    v_mfma_f32_16x16x32_bf16 v[108:111], v[124:127], v[148:151], v[108:111]
    s_waitcnt lgkmcnt(9)
    v_mfma_f32_16x16x32_bf16 v[48:51], v[176:179], v[152:155], v[48:51]
    s_waitcnt lgkmcnt(8)
    v_mfma_f32_16x16x32_bf16 v[52:55], v[176:179], v[156:159], v[52:55]
    s_barrier
    s_waitcnt lgkmcnt(7)
    v_mfma_f32_16x16x32_bf16 v[56:59], v[176:179], v[160:163], v[56:59]
    ds_read_b128 v[112:115], v196 offset:0
    s_waitcnt lgkmcnt(7)
    v_mfma_f32_16x16x32_bf16 v[60:63], v[176:179], v[164:167], v[60:63]
    ds_read_b64_tr_b16 v[136:137], v198 offset:8192
    s_waitcnt lgkmcnt(6)
    v_mfma_f32_16x16x32_bf16 v[64:67], v[180:183], v[152:155], v[64:67]
    ds_read_b64_tr_b16 v[138:139], v198 offset:8704
    v_mfma_f32_16x16x32_bf16 v[68:71], v[180:183], v[156:159], v[68:71]
    ds_read_b128 v[116:119], v196 offset:2048
    v_mfma_f32_16x16x32_bf16 v[72:75], v[180:183], v[160:163], v[72:75]
    ds_read_b128 v[120:123], v196 offset:4096
    v_mfma_f32_16x16x32_bf16 v[76:79], v[180:183], v[164:167], v[76:79]
    ds_read_b128 v[124:127], v196 offset:6144
    s_waitcnt lgkmcnt(8)
    v_mfma_f32_16x16x32_bf16 v[80:83], v[152:155], v[184:187], v[80:83]
    ds_read_b64_tr_b16 v[140:141], v199 offset:8192
    v_mfma_f32_16x16x32_bf16 v[84:87], v[156:159], v[184:187], v[84:87]
    ds_read_b64_tr_b16 v[142:143], v199 offset:8704
    v_mfma_f32_16x16x32_bf16 v[88:91], v[160:163], v[184:187], v[88:91]
    ds_read_b64_tr_b16 v[144:145], v198 offset:16384
    v_mfma_f32_16x16x32_bf16 v[92:95], v[164:167], v[184:187], v[92:95]
    ds_read_b64_tr_b16 v[146:147], v198 offset:16896
    s_waitcnt lgkmcnt(10)
    v_mfma_f32_16x16x32_bf16 v[96:99], v[152:155], v[188:191], v[96:99]
    ds_read_b64_tr_b16 v[148:149], v199 offset:16384
    v_mfma_f32_16x16x32_bf16 v[100:103], v[156:159], v[188:191], v[100:103]
    ds_read_b64_tr_b16 v[150:151], v199 offset:16896
    v_mfma_f32_16x16x32_bf16 v[104:107], v[160:163], v[188:191], v[104:107]
    v_mfma_f32_16x16x32_bf16 v[108:111], v[164:167], v[188:191], v[108:111]
    s_waitcnt lgkmcnt(9)
    v_mfma_f32_16x16x32_bf16 v[48:51], v[136:139], v[112:115], v[48:51]
    ds_read_b128 v[152:155], v197 offset:0
    s_waitcnt lgkmcnt(9)
    v_mfma_f32_16x16x32_bf16 v[52:55], v[136:139], v[116:119], v[52:55]
    ds_read_b64_tr_b16 v[176:177], v198 offset:12288
    s_waitcnt lgkmcnt(9)
    v_mfma_f32_16x16x32_bf16 v[56:59], v[136:139], v[120:123], v[56:59]
    ds_read_b64_tr_b16 v[178:179], v198 offset:12800
    s_waitcnt lgkmcnt(9)
    v_mfma_f32_16x16x32_bf16 v[60:63], v[136:139], v[124:127], v[60:63]
    ds_read_b128 v[156:159], v197 offset:2048
    s_waitcnt lgkmcnt(8)
    v_mfma_f32_16x16x32_bf16 v[64:67], v[140:143], v[112:115], v[64:67]
    ds_read_b128 v[160:163], v197 offset:4096
    v_mfma_f32_16x16x32_bf16 v[68:71], v[140:143], v[116:119], v[68:71]
    ds_read_b128 v[164:167], v197 offset:6144
    v_mfma_f32_16x16x32_bf16 v[72:75], v[140:143], v[120:123], v[72:75]
    ds_read_b64_tr_b16 v[180:181], v199 offset:12288
    v_mfma_f32_16x16x32_bf16 v[76:79], v[140:143], v[124:127], v[76:79]
    ds_read_b64_tr_b16 v[182:183], v199 offset:12800
    s_waitcnt lgkmcnt(10)
    v_mfma_f32_16x16x32_bf16 v[80:83], v[112:115], v[144:147], v[80:83]
    ds_read_b64_tr_b16 v[184:185], v198 offset:20480
    v_mfma_f32_16x16x32_bf16 v[84:87], v[116:119], v[144:147], v[84:87]
    ds_read_b64_tr_b16 v[186:187], v198 offset:20992
    v_mfma_f32_16x16x32_bf16 v[88:91], v[120:123], v[144:147], v[88:91]
    ds_read_b64_tr_b16 v[188:189], v199 offset:20480
    v_mfma_f32_16x16x32_bf16 v[92:95], v[124:127], v[144:147], v[92:95]
    ds_read_b64_tr_b16 v[190:191], v199 offset:20992
    s_waitcnt lgkmcnt(12)
    v_mfma_f32_16x16x32_bf16 v[96:99], v[112:115], v[148:151], v[96:99]
    v_mfma_f32_16x16x32_bf16 v[100:103], v[116:119], v[148:151], v[100:103]
    v_mfma_f32_16x16x32_bf16 v[104:107], v[120:123], v[148:151], v[104:107]
    v_mfma_f32_16x16x32_bf16 v[108:111], v[124:127], v[148:151], v[108:111]
    s_waitcnt lgkmcnt(9)
    v_mfma_f32_16x16x32_bf16 v[48:51], v[176:179], v[152:155], v[48:51]
    s_waitcnt lgkmcnt(8)
    v_mfma_f32_16x16x32_bf16 v[52:55], v[176:179], v[156:159], v[52:55]
    s_barrier
    s_waitcnt lgkmcnt(7)
    v_mfma_f32_16x16x32_bf16 v[56:59], v[176:179], v[160:163], v[56:59]
    ds_read_b128 v[112:115], v200 offset:0
    s_waitcnt lgkmcnt(7)
    v_mfma_f32_16x16x32_bf16 v[60:63], v[176:179], v[164:167], v[60:63]
    ds_read_b64_tr_b16 v[136:137], v202 offset:8192
    s_waitcnt lgkmcnt(6)
    v_mfma_f32_16x16x32_bf16 v[64:67], v[180:183], v[152:155], v[64:67]
    ds_read_b64_tr_b16 v[138:139], v202 offset:8704
    v_mfma_f32_16x16x32_bf16 v[68:71], v[180:183], v[156:159], v[68:71]
    ds_read_b128 v[116:119], v200 offset:2048
    v_mfma_f32_16x16x32_bf16 v[72:75], v[180:183], v[160:163], v[72:75]
    ds_read_b128 v[120:123], v200 offset:4096
    v_mfma_f32_16x16x32_bf16 v[76:79], v[180:183], v[164:167], v[76:79]
    ds_read_b128 v[124:127], v200 offset:6144
    s_waitcnt lgkmcnt(8)
    v_mfma_f32_16x16x32_bf16 v[80:83], v[152:155], v[184:187], v[80:83]
    ds_read_b64_tr_b16 v[140:141], v203 offset:8192
    v_mfma_f32_16x16x32_bf16 v[84:87], v[156:159], v[184:187], v[84:87]
    ds_read_b64_tr_b16 v[142:143], v203 offset:8704
    v_mfma_f32_16x16x32_bf16 v[88:91], v[160:163], v[184:187], v[88:91]
    ds_read_b64_tr_b16 v[144:145], v202 offset:16384
    v_mfma_f32_16x16x32_bf16 v[92:95], v[164:167], v[184:187], v[92:95]
    ds_read_b64_tr_b16 v[146:147], v202 offset:16896
    s_waitcnt lgkmcnt(10)
    v_mfma_f32_16x16x32_bf16 v[96:99], v[152:155], v[188:191], v[96:99]
    ds_read_b64_tr_b16 v[148:149], v203 offset:16384
    v_mfma_f32_16x16x32_bf16 v[100:103], v[156:159], v[188:191], v[100:103]
    ds_read_b64_tr_b16 v[150:151], v203 offset:16896
    v_mfma_f32_16x16x32_bf16 v[104:107], v[160:163], v[188:191], v[104:107]
    v_mfma_f32_16x16x32_bf16 v[108:111], v[164:167], v[188:191], v[108:111]
    s_waitcnt lgkmcnt(9)
    v_mfma_f32_16x16x32_bf16 v[48:51], v[136:139], v[112:115], v[48:51]
    ds_read_b128 v[152:155], v201 offset:0
    s_waitcnt lgkmcnt(9)
    v_mfma_f32_16x16x32_bf16 v[52:55], v[136:139], v[116:119], v[52:55]
    ds_read_b64_tr_b16 v[176:177], v202 offset:12288
    s_waitcnt lgkmcnt(9)
    v_mfma_f32_16x16x32_bf16 v[56:59], v[136:139], v[120:123], v[56:59]
    ds_read_b64_tr_b16 v[178:179], v202 offset:12800
    s_waitcnt lgkmcnt(9)
    v_mfma_f32_16x16x32_bf16 v[60:63], v[136:139], v[124:127], v[60:63]
    ds_read_b128 v[156:159], v201 offset:2048
    s_waitcnt lgkmcnt(8)
    v_mfma_f32_16x16x32_bf16 v[64:67], v[140:143], v[112:115], v[64:67]
    ds_read_b128 v[160:163], v201 offset:4096
    v_mfma_f32_16x16x32_bf16 v[68:71], v[140:143], v[116:119], v[68:71]
    ds_read_b128 v[164:167], v201 offset:6144
    v_mfma_f32_16x16x32_bf16 v[72:75], v[140:143], v[120:123], v[72:75]
    ds_read_b64_tr_b16 v[180:181], v203 offset:12288
    v_mfma_f32_16x16x32_bf16 v[76:79], v[140:143], v[124:127], v[76:79]
    ds_read_b64_tr_b16 v[182:183], v203 offset:12800
    s_waitcnt lgkmcnt(10)
    v_mfma_f32_16x16x32_bf16 v[80:83], v[112:115], v[144:147], v[80:83]
    ds_read_b64_tr_b16 v[184:185], v202 offset:20480
    v_mfma_f32_16x16x32_bf16 v[84:87], v[116:119], v[144:147], v[84:87]
    ds_read_b64_tr_b16 v[186:187], v202 offset:20992
    v_mfma_f32_16x16x32_bf16 v[88:91], v[120:123], v[144:147], v[88:91]
    ds_read_b64_tr_b16 v[188:189], v203 offset:20480
    v_mfma_f32_16x16x32_bf16 v[92:95], v[124:127], v[144:147], v[92:95]
    ds_read_b64_tr_b16 v[190:191], v203 offset:20992
    s_waitcnt lgkmcnt(12)
    v_mfma_f32_16x16x32_bf16 v[96:99], v[112:115], v[148:151], v[96:99]
    v_mfma_f32_16x16x32_bf16 v[100:103], v[116:119], v[148:151], v[100:103]
    v_mfma_f32_16x16x32_bf16 v[104:107], v[120:123], v[148:151], v[104:107]
    v_mfma_f32_16x16x32_bf16 v[108:111], v[124:127], v[148:151], v[108:111]
    s_waitcnt lgkmcnt(9)
    v_mfma_f32_16x16x32_bf16 v[48:51], v[176:179], v[152:155], v[48:51]
    s_waitcnt lgkmcnt(8)
    v_mfma_f32_16x16x32_bf16 v[52:55], v[176:179], v[156:159], v[52:55]
    s_barrier
    v_mov_b32 v1, 24576
    ds_read_b64 v[236:237], v1
    s_waitcnt lgkmcnt(8)
    v_mfma_f32_16x16x32_bf16 v[56:59], v[176:179], v[160:163], v[56:59]
    ds_read_b128 v[112:115], v204 offset:0
    s_waitcnt lgkmcnt(8)
    v_mfma_f32_16x16x32_bf16 v[60:63], v[176:179], v[164:167], v[60:63]
    ds_read_b64_tr_b16 v[136:137], v206 offset:8192
    s_waitcnt lgkmcnt(7)
    v_mfma_f32_16x16x32_bf16 v[64:67], v[180:183], v[152:155], v[64:67]
    ds_read_b64_tr_b16 v[138:139], v206 offset:8704
    v_mfma_f32_16x16x32_bf16 v[68:71], v[180:183], v[156:159], v[68:71]
    ds_read_b128 v[116:119], v204 offset:2048
    v_mfma_f32_16x16x32_bf16 v[72:75], v[180:183], v[160:163], v[72:75]
    ds_read_b128 v[120:123], v204 offset:4096
    v_mfma_f32_16x16x32_bf16 v[76:79], v[180:183], v[164:167], v[76:79]
    ds_read_b128 v[124:127], v204 offset:6144
    s_waitcnt lgkmcnt(9)
    v_mfma_f32_16x16x32_bf16 v[80:83], v[152:155], v[184:187], v[80:83]
    ds_read_b64_tr_b16 v[140:141], v207 offset:8192
    v_mfma_f32_16x16x32_bf16 v[84:87], v[156:159], v[184:187], v[84:87]
    ds_read_b64_tr_b16 v[142:143], v207 offset:8704
    v_mfma_f32_16x16x32_bf16 v[88:91], v[160:163], v[184:187], v[88:91]
    ds_read_b64_tr_b16 v[144:145], v206 offset:16384
    v_mfma_f32_16x16x32_bf16 v[92:95], v[164:167], v[184:187], v[92:95]
    ds_read_b64_tr_b16 v[146:147], v206 offset:16896
    s_waitcnt lgkmcnt(11)
    v_mfma_f32_16x16x32_bf16 v[96:99], v[152:155], v[188:191], v[96:99]
    ds_read_b64_tr_b16 v[148:149], v207 offset:16384
    v_mfma_f32_16x16x32_bf16 v[100:103], v[156:159], v[188:191], v[100:103]
    ds_read_b64_tr_b16 v[150:151], v207 offset:16896
    v_mfma_f32_16x16x32_bf16 v[104:107], v[160:163], v[188:191], v[104:107]
    v_mfma_f32_16x16x32_bf16 v[108:111], v[164:167], v[188:191], v[108:111]
    s_waitcnt lgkmcnt(9)
    v_mfma_f32_16x16x32_bf16 v[48:51], v[136:139], v[112:115], v[48:51]
    ds_read_b128 v[152:155], v205 offset:0
    s_waitcnt lgkmcnt(9)
    v_mfma_f32_16x16x32_bf16 v[52:55], v[136:139], v[116:119], v[52:55]
    ds_read_b64_tr_b16 v[176:177], v206 offset:12288
    s_waitcnt lgkmcnt(9)
    v_mfma_f32_16x16x32_bf16 v[56:59], v[136:139], v[120:123], v[56:59]
    ds_read_b64_tr_b16 v[178:179], v206 offset:12800
    s_waitcnt lgkmcnt(9)
    v_mfma_f32_16x16x32_bf16 v[60:63], v[136:139], v[124:127], v[60:63]
    ds_read_b128 v[156:159], v205 offset:2048
    s_waitcnt lgkmcnt(8)
    v_mfma_f32_16x16x32_bf16 v[64:67], v[140:143], v[112:115], v[64:67]
    ds_read_b128 v[160:163], v205 offset:4096
    v_mfma_f32_16x16x32_bf16 v[68:71], v[140:143], v[116:119], v[68:71]
    ds_read_b128 v[164:167], v205 offset:6144
    v_mfma_f32_16x16x32_bf16 v[72:75], v[140:143], v[120:123], v[72:75]
    ds_read_b64_tr_b16 v[180:181], v207 offset:12288
    v_mfma_f32_16x16x32_bf16 v[76:79], v[140:143], v[124:127], v[76:79]
    ds_read_b64_tr_b16 v[182:183], v207 offset:12800
    s_waitcnt lgkmcnt(10)
    v_mfma_f32_16x16x32_bf16 v[80:83], v[112:115], v[144:147], v[80:83]
    ds_read_b64_tr_b16 v[184:185], v206 offset:20480
    v_mfma_f32_16x16x32_bf16 v[84:87], v[116:119], v[144:147], v[84:87]
    ds_read_b64_tr_b16 v[186:187], v206 offset:20992
    v_mfma_f32_16x16x32_bf16 v[88:91], v[120:123], v[144:147], v[88:91]
    ds_read_b64_tr_b16 v[188:189], v207 offset:20480
    v_mfma_f32_16x16x32_bf16 v[92:95], v[124:127], v[144:147], v[92:95]
    ds_read_b64_tr_b16 v[190:191], v207 offset:20992
    s_waitcnt lgkmcnt(12)
    v_mfma_f32_16x16x32_bf16 v[96:99], v[112:115], v[148:151], v[96:99]
    v_mfma_f32_16x16x32_bf16 v[100:103], v[116:119], v[148:151], v[100:103]
    v_mfma_f32_16x16x32_bf16 v[104:107], v[120:123], v[148:151], v[104:107]
    v_mfma_f32_16x16x32_bf16 v[108:111], v[124:127], v[148:151], v[108:111]
    s_waitcnt lgkmcnt(9)
    v_mfma_f32_16x16x32_bf16 v[48:51], v[176:179], v[152:155], v[48:51]
    ds_read_b128 v[112:115], v192 offset:0
    s_waitcnt lgkmcnt(9)
    v_mfma_f32_16x16x32_bf16 v[52:55], v[176:179], v[156:159], v[52:55]
    ds_read_b64_tr_b16 v[128:129], v194 offset:0
    s_waitcnt lgkmcnt(9)
    v_mfma_f32_16x16x32_bf16 v[56:59], v[176:179], v[160:163], v[56:59]
    ds_read_b64_tr_b16 v[130:131], v194 offset:512
    s_waitcnt lgkmcnt(9)
    v_mfma_f32_16x16x32_bf16 v[60:63], v[176:179], v[164:167], v[60:63]
    ds_read_b128 v[116:119], v192 offset:2048
    s_waitcnt lgkmcnt(8)
    v_mfma_f32_16x16x32_bf16 v[64:67], v[180:183], v[152:155], v[64:67]
    ds_read_b128 v[120:123], v192 offset:4096
    v_mfma_f32_16x16x32_bf16 v[68:71], v[180:183], v[156:159], v[68:71]
    ds_read_b128 v[124:127], v192 offset:6144
    v_mfma_f32_16x16x32_bf16 v[72:75], v[180:183], v[160:163], v[72:75]
    ds_read_b64_tr_b16 v[132:133], v195 offset:0
    v_mfma_f32_16x16x32_bf16 v[76:79], v[180:183], v[164:167], v[76:79]
    ds_read_b64_tr_b16 v[134:135], v195 offset:512
    s_waitcnt lgkmcnt(10)
    v_mfma_f32_16x16x32_bf16 v[80:83], v[152:155], v[184:187], v[80:83]
    v_mfma_f32_16x16x32_bf16 v[84:87], v[156:159], v[184:187], v[84:87]
    v_mfma_f32_16x16x32_bf16 v[88:91], v[160:163], v[184:187], v[88:91]
    v_mfma_f32_16x16x32_bf16 v[92:95], v[164:167], v[184:187], v[92:95]
    s_waitcnt lgkmcnt(8)
    v_mfma_f32_16x16x32_bf16 v[96:99], v[152:155], v[188:191], v[96:99]
    v_mfma_f32_16x16x32_bf16 v[100:103], v[156:159], v[188:191], v[100:103]
    v_mfma_f32_16x16x32_bf16 v[104:107], v[160:163], v[188:191], v[104:107]
    v_mfma_f32_16x16x32_bf16 v[108:111], v[164:167], v[188:191], v[108:111]
    v_readfirstlane_b32 s60, v236
    v_readfirstlane_b32 s61, v237
    s_waitcnt lgkmcnt(5)
    v_mfma_f32_16x16x32_bf16 v[16:19], v[128:131], v[112:115], v[16:19]
    ds_read_b128 v[152:155], v193 offset:0
    v_cvt_pk_bf16_f32 v208, v48, v49
    v_cvt_pk_bf16_f32 v210, v52, v53
    v_cvt_pk_bf16_f32 v209, v50, v51
    v_cvt_pk_bf16_f32 v211, v54, v55
    s_waitcnt lgkmcnt(5)
    v_mfma_f32_16x16x32_bf16 v[20:23], v[128:131], v[116:119], v[20:23]
    ds_read_b64_tr_b16 v[168:169], v194 offset:4096
    v_cvt_pk_bf16_f32 v212, v64, v65
    v_cvt_pk_bf16_f32 v214, v68, v69
    v_cvt_pk_bf16_f32 v213, v66, v67
    v_cvt_pk_bf16_f32 v215, v70, v71
    s_waitcnt lgkmcnt(5)
    v_mfma_f32_16x16x32_bf16 v[24:27], v[128:131], v[120:123], v[24:27]
    ds_read_b64_tr_b16 v[170:171], v194 offset:4608
    v_cvt_pk_bf16_f32 v224, v56, v57
    v_cvt_pk_bf16_f32 v226, v60, v61
    v_cvt_pk_bf16_f32 v225, v58, v59
    v_cvt_pk_bf16_f32 v227, v62, v63
    s_waitcnt lgkmcnt(5)
    v_mfma_f32_16x16x32_bf16 v[28:31], v[128:131], v[124:127], v[28:31]
    ds_read_b128 v[156:159], v193 offset:2048
    v_cvt_pk_bf16_f32 v228, v72, v73
    v_cvt_pk_bf16_f32 v230, v76, v77
    v_cvt_pk_bf16_f32 v229, v74, v75
    v_cvt_pk_bf16_f32 v231, v78, v79
    s_waitcnt lgkmcnt(4)
    v_mfma_f32_16x16x32_bf16 v[32:35], v[132:135], v[112:115], v[32:35]
    ds_read_b128 v[160:163], v193 offset:4096
    v_permlane16_swap_b32 v208, v210
    v_permlane16_swap_b32 v209, v211
    v_permlane16_swap_b32 v212, v214
    v_permlane16_swap_b32 v213, v215
    v_mfma_f32_16x16x32_bf16 v[36:39], v[132:135], v[116:119], v[36:39]
    ds_read_b128 v[164:167], v193 offset:6144
    v_permlane16_swap_b32 v224, v226
    v_permlane16_swap_b32 v225, v227
    v_permlane16_swap_b32 v228, v230
    v_permlane16_swap_b32 v229, v231
    v_mfma_f32_16x16x32_bf16 v[40:43], v[132:135], v[120:123], v[40:43]
    ds_read_b64_tr_b16 v[172:173], v195 offset:4096
    v_cvt_pk_bf16_f32 v216, v80, v81
    v_cvt_pk_bf16_f32 v218, v96, v97
    v_cvt_pk_bf16_f32 v217, v82, v83
    v_cvt_pk_bf16_f32 v219, v98, v99
    v_mfma_f32_16x16x32_bf16 v[44:47], v[132:135], v[124:127], v[44:47]
    ds_read_b64_tr_b16 v[174:175], v195 offset:4608
    buffer_store_dwordx4 v[208:211], v3, s[32:35], s64 offen offset:0 sc1
    v_cvt_pk_bf16_f32 v220, v84, v85
    v_cvt_pk_bf16_f32 v222, v100, v101
    v_cvt_pk_bf16_f32 v221, v86, v87
    s_waitcnt lgkmcnt(5)
    v_mfma_f32_16x16x32_bf16 v[16:19], v[168:171], v[152:155], v[16:19]
    ds_read_b128 v[112:115], v196 offset:0
    v_cvt_pk_bf16_f32 v223, v102, v103
    buffer_store_dwordx4 v[212:215], v3, s[32:35], s64 offen offset:1024 sc1
    v_cvt_pk_bf16_f32 v232, v88, v89
    v_cvt_pk_bf16_f32 v234, v104, v105
    s_waitcnt lgkmcnt(5)
    v_mfma_f32_16x16x32_bf16 v[20:23], v[168:171], v[156:159], v[20:23]
    ds_read_b64_tr_b16 v[128:129], v198 offset:0
    v_cvt_pk_bf16_f32 v233, v90, v91
    v_cvt_pk_bf16_f32 v235, v106, v107
    buffer_store_dwordx4 v[224:227], v3, s[32:35], s49 offen offset:0 sc1
    v_cvt_pk_bf16_f32 v236, v92, v93
    s_waitcnt lgkmcnt(5)
    v_mfma_f32_16x16x32_bf16 v[24:27], v[168:171], v[160:163], v[24:27]
    ds_read_b64_tr_b16 v[130:131], v198 offset:512
    v_cvt_pk_bf16_f32 v238, v108, v109
    v_cvt_pk_bf16_f32 v237, v94, v95
    v_cvt_pk_bf16_f32 v239, v110, v111
    buffer_store_dwordx4 v[228:231], v3, s[32:35], s49 offen offset:1024 sc1
    s_waitcnt lgkmcnt(5)
    v_mfma_f32_16x16x32_bf16 v[28:31], v[168:171], v[164:167], v[28:31]
    ds_read_b128 v[116:119], v196 offset:2048
    v_permlane16_swap_b32 v216, v218
    v_permlane16_swap_b32 v217, v219
    v_permlane16_swap_b32 v220, v222
    v_permlane16_swap_b32 v221, v223
    s_waitcnt lgkmcnt(4)
    v_mfma_f32_16x16x32_bf16 v[32:35], v[172:175], v[152:155], v[32:35]
    ds_read_b128 v[120:123], v196 offset:4096
    v_permlane16_swap_b32 v232, v234
    v_permlane16_swap_b32 v233, v235
    v_permlane16_swap_b32 v236, v238
    v_permlane16_swap_b32 v237, v239
    v_mfma_f32_16x16x32_bf16 v[36:39], v[172:175], v[156:159], v[36:39]
    ds_read_b128 v[124:127], v196 offset:6144
    v_permlane32_swap_b32 v216, v218
    v_permlane32_swap_b32 v217, v219
    buffer_store_dwordx4 v[216:219], v3, s[32:35], s64 offen offset:2048 sc1
    v_permlane32_swap_b32 v220, v222
    v_mfma_f32_16x16x32_bf16 v[40:43], v[172:175], v[160:163], v[40:43]
    ds_read_b64_tr_b16 v[132:133], v199 offset:0
    v_permlane32_swap_b32 v221, v223
    buffer_store_dwordx4 v[220:223], v3, s[32:35], s64 offen offset:3072 sc1
    v_permlane32_swap_b32 v232, v234
    v_permlane32_swap_b32 v233, v235
    v_mfma_f32_16x16x32_bf16 v[44:47], v[172:175], v[164:167], v[44:47]
    ds_read_b64_tr_b16 v[134:135], v199 offset:512
    buffer_store_dwordx4 v[232:235], v3, s[32:35], s49 offen offset:2048 sc1
    v_permlane32_swap_b32 v236, v238
    v_permlane32_swap_b32 v237, v239
    buffer_store_dwordx4 v[236:239], v3, s[32:35], s49 offen offset:3072 sc1
    s_waitcnt lgkmcnt(5)
    v_mfma_f32_16x16x32_bf16 v[16:19], v[128:131], v[112:115], v[16:19]
    ds_read_b128 v[152:155], v197 offset:0
    s_waitcnt lgkmcnt(5)
    v_mfma_f32_16x16x32_bf16 v[20:23], v[128:131], v[116:119], v[20:23]
    ds_read_b64_tr_b16 v[168:169], v198 offset:4096
    s_waitcnt lgkmcnt(5)
    v_mfma_f32_16x16x32_bf16 v[24:27], v[128:131], v[120:123], v[24:27]
    ds_read_b64_tr_b16 v[170:171], v198 offset:4608
    s_waitcnt lgkmcnt(5)
    v_mfma_f32_16x16x32_bf16 v[28:31], v[128:131], v[124:127], v[28:31]
    ds_read_b128 v[156:159], v197 offset:2048
    s_waitcnt lgkmcnt(4)
    v_mfma_f32_16x16x32_bf16 v[32:35], v[132:135], v[112:115], v[32:35]
    ds_read_b128 v[160:163], v197 offset:4096
    v_mfma_f32_16x16x32_bf16 v[36:39], v[132:135], v[116:119], v[36:39]
    ds_read_b128 v[164:167], v197 offset:6144
    v_mfma_f32_16x16x32_bf16 v[40:43], v[132:135], v[120:123], v[40:43]
    ds_read_b64_tr_b16 v[172:173], v199 offset:4096
    v_mfma_f32_16x16x32_bf16 v[44:47], v[132:135], v[124:127], v[44:47]
    ds_read_b64_tr_b16 v[174:175], v199 offset:4608
    s_waitcnt lgkmcnt(5)
    v_mfma_f32_16x16x32_bf16 v[16:19], v[168:171], v[152:155], v[16:19]
    ds_read_b128 v[112:115], v200 offset:0
    s_waitcnt lgkmcnt(5)
    v_mfma_f32_16x16x32_bf16 v[20:23], v[168:171], v[156:159], v[20:23]
    ds_read_b64_tr_b16 v[128:129], v202 offset:0
    s_waitcnt lgkmcnt(5)
    v_mfma_f32_16x16x32_bf16 v[24:27], v[168:171], v[160:163], v[24:27]
    ds_read_b64_tr_b16 v[130:131], v202 offset:512
    s_waitcnt lgkmcnt(5)
    v_mfma_f32_16x16x32_bf16 v[28:31], v[168:171], v[164:167], v[28:31]
    ds_read_b128 v[116:119], v200 offset:2048
    s_waitcnt lgkmcnt(4)
    v_mfma_f32_16x16x32_bf16 v[32:35], v[172:175], v[152:155], v[32:35]
    ds_read_b128 v[120:123], v200 offset:4096
    v_mfma_f32_16x16x32_bf16 v[36:39], v[172:175], v[156:159], v[36:39]
    ds_read_b128 v[124:127], v200 offset:6144
    v_mfma_f32_16x16x32_bf16 v[40:43], v[172:175], v[160:163], v[40:43]
    ds_read_b64_tr_b16 v[132:133], v203 offset:0
    v_mfma_f32_16x16x32_bf16 v[44:47], v[172:175], v[164:167], v[44:47]
    ds_read_b64_tr_b16 v[134:135], v203 offset:512
    s_waitcnt lgkmcnt(5)
    v_mfma_f32_16x16x32_bf16 v[16:19], v[128:131], v[112:115], v[16:19]
    ds_read_b128 v[152:155], v201 offset:0
    s_waitcnt lgkmcnt(5)
    v_mfma_f32_16x16x32_bf16 v[20:23], v[128:131], v[116:119], v[20:23]
    ds_read_b64_tr_b16 v[168:169], v202 offset:4096
    s_waitcnt lgkmcnt(5)
    v_mfma_f32_16x16x32_bf16 v[24:27], v[128:131], v[120:123], v[24:27]
    ds_read_b64_tr_b16 v[170:171], v202 offset:4608
    s_waitcnt lgkmcnt(5)
    v_mfma_f32_16x16x32_bf16 v[28:31], v[128:131], v[124:127], v[28:31]
    ds_read_b128 v[156:159], v201 offset:2048
    s_waitcnt lgkmcnt(4)
    v_mfma_f32_16x16x32_bf16 v[32:35], v[132:135], v[112:115], v[32:35]
    ds_read_b128 v[160:163], v201 offset:4096
    v_mfma_f32_16x16x32_bf16 v[36:39], v[132:135], v[116:119], v[36:39]
    ds_read_b128 v[164:167], v201 offset:6144
    v_mfma_f32_16x16x32_bf16 v[40:43], v[132:135], v[120:123], v[40:43]
    ds_read_b64_tr_b16 v[172:173], v203 offset:4096
    v_mfma_f32_16x16x32_bf16 v[44:47], v[132:135], v[124:127], v[44:47]
    ds_read_b64_tr_b16 v[174:175], v203 offset:4608
    s_waitcnt lgkmcnt(5)
    v_mfma_f32_16x16x32_bf16 v[16:19], v[168:171], v[152:155], v[16:19]
    ds_read_b128 v[112:115], v204 offset:0
    s_waitcnt lgkmcnt(5)
    v_mfma_f32_16x16x32_bf16 v[20:23], v[168:171], v[156:159], v[20:23]
    ds_read_b64_tr_b16 v[128:129], v206 offset:0
    s_waitcnt lgkmcnt(5)
    v_mfma_f32_16x16x32_bf16 v[24:27], v[168:171], v[160:163], v[24:27]
    ds_read_b64_tr_b16 v[130:131], v206 offset:512
    s_waitcnt lgkmcnt(5)
    v_mfma_f32_16x16x32_bf16 v[28:31], v[168:171], v[164:167], v[28:31]
    ds_read_b128 v[116:119], v204 offset:2048
    s_waitcnt lgkmcnt(4)
    v_mfma_f32_16x16x32_bf16 v[32:35], v[172:175], v[152:155], v[32:35]
    ds_read_b128 v[120:123], v204 offset:4096
    v_mfma_f32_16x16x32_bf16 v[36:39], v[172:175], v[156:159], v[36:39]
    ds_read_b128 v[124:127], v204 offset:6144
    v_mfma_f32_16x16x32_bf16 v[40:43], v[172:175], v[160:163], v[40:43]
    ds_read_b64_tr_b16 v[132:133], v207 offset:0
    v_mfma_f32_16x16x32_bf16 v[44:47], v[172:175], v[164:167], v[44:47]
    ds_read_b64_tr_b16 v[134:135], v207 offset:512
    s_waitcnt lgkmcnt(5)
    v_mfma_f32_16x16x32_bf16 v[16:19], v[128:131], v[112:115], v[16:19]
    ds_read_b128 v[152:155], v205 offset:0
    s_waitcnt lgkmcnt(5)
    v_mfma_f32_16x16x32_bf16 v[20:23], v[128:131], v[116:119], v[20:23]
    ds_read_b64_tr_b16 v[168:169], v206 offset:4096
    s_waitcnt lgkmcnt(5)
    v_mfma_f32_16x16x32_bf16 v[24:27], v[128:131], v[120:123], v[24:27]
    ds_read_b64_tr_b16 v[170:171], v206 offset:4608
    s_waitcnt lgkmcnt(5)
    v_mfma_f32_16x16x32_bf16 v[28:31], v[128:131], v[124:127], v[28:31]
    ds_read_b128 v[156:159], v205 offset:2048
    s_waitcnt lgkmcnt(4)
    v_mfma_f32_16x16x32_bf16 v[32:35], v[132:135], v[112:115], v[32:35]
    ds_read_b128 v[160:163], v205 offset:4096
    v_mfma_f32_16x16x32_bf16 v[36:39], v[132:135], v[116:119], v[36:39]
    ds_read_b128 v[164:167], v205 offset:6144
    v_mfma_f32_16x16x32_bf16 v[40:43], v[132:135], v[120:123], v[40:43]
    ds_read_b64_tr_b16 v[172:173], v207 offset:4096
    v_mfma_f32_16x16x32_bf16 v[44:47], v[132:135], v[124:127], v[44:47]
    ds_read_b64_tr_b16 v[174:175], v207 offset:4608
    s_waitcnt lgkmcnt(5)
    v_mfma_f32_16x16x32_bf16 v[16:19], v[168:171], v[152:155], v[16:19]
    s_waitcnt lgkmcnt(4)
    v_mfma_f32_16x16x32_bf16 v[20:23], v[168:171], v[156:159], v[20:23]
    s_waitcnt lgkmcnt(3)
    v_mfma_f32_16x16x32_bf16 v[24:27], v[168:171], v[160:163], v[24:27]
    s_waitcnt lgkmcnt(2)
    v_mfma_f32_16x16x32_bf16 v[28:31], v[168:171], v[164:167], v[28:31]
    s_waitcnt lgkmcnt(0)
    v_mfma_f32_16x16x32_bf16 v[32:35], v[172:175], v[152:155], v[32:35]
    v_mfma_f32_16x16x32_bf16 v[36:39], v[172:175], v[156:159], v[36:39]
    s_barrier
    v_mfma_f32_16x16x32_bf16 v[40:43], v[172:175], v[160:163], v[40:43]
    v_mfma_f32_16x16x32_bf16 v[44:47], v[172:175], v[164:167], v[44:47]
    s_nop 7
    s_cmp_eq_u32 s45, 1
    s_cbranch_scc1 L_p1
    s_getreg_b32 s58, hwreg(HW_REG_IB_STS, 0, 4)
    s_or_b32 s58, s58, s74
    s_cmp_eq_u32 s58, 0
    s_cbranch_scc1 Ltg_3
Ltb_4:
    s_mov_b32 s56, 0x3e8293ee
    s_mov_b32 s57, 0x3e8293ee
    v_pk_mul_f32 v[16:17], v[16:17], s[56:57]
    v_pk_mul_f32 v[18:19], v[18:19], s[56:57]
    v_pk_mul_f32 v[20:21], v[20:21], s[56:57]
    v_pk_mul_f32 v[22:23], v[22:23], s[56:57]
    v_pk_mul_f32 v[24:25], v[24:25], s[56:57]
    v_pk_mul_f32 v[26:27], v[26:27], s[56:57]
    v_pk_mul_f32 v[28:29], v[28:29], s[56:57]
    v_pk_mul_f32 v[30:31], v[30:31], s[56:57]
    v_pk_mul_f32 v[32:33], v[32:33], s[56:57]
    v_pk_mul_f32 v[34:35], v[34:35], s[56:57]
    v_pk_mul_f32 v[36:37], v[36:37], s[56:57]
    v_pk_mul_f32 v[38:39], v[38:39], s[56:57]
    v_pk_mul_f32 v[40:41], v[40:41], s[56:57]
    v_pk_mul_f32 v[42:43], v[42:43], s[56:57]
    v_pk_mul_f32 v[44:45], v[44:45], s[56:57]
    v_pk_mul_f32 v[46:47], v[46:47], s[56:57]
    v_cvt_pk_bf16_f32 v144, v16, v17
    v_cvt_pk_bf16_f32 v146, v20, v21
    v_cvt_pk_bf16_f32 v145, v18, v19
    v_cvt_pk_bf16_f32 v147, v22, v23
    v_cvt_pk_bf16_f32 v148, v32, v33
    v_cvt_pk_bf16_f32 v150, v36, v37
    v_cvt_pk_bf16_f32 v149, v34, v35
    v_cvt_pk_bf16_f32 v151, v38, v39
    v_cvt_pk_bf16_f32 v152, v24, v25
    v_cvt_pk_bf16_f32 v154, v28, v29
    v_cvt_pk_bf16_f32 v153, v26, v27
    v_cvt_pk_bf16_f32 v155, v30, v31
    v_cvt_pk_bf16_f32 v156, v40, v41
    v_cvt_pk_bf16_f32 v158, v44, v45
    v_cvt_pk_bf16_f32 v157, v42, v43
    v_cvt_pk_bf16_f32 v159, v46, v47
    s_lshl_b32 s58, s44, 13
    v_add_u32 v8, s58, v3
    v_permlane16_swap_b32 v144, v146
    v_permlane16_swap_b32 v145, v147
    v_permlane16_swap_b32 v148, v150
    v_permlane16_swap_b32 v149, v151
    v_permlane16_swap_b32 v152, v154
    v_permlane16_swap_b32 v153, v155
    v_permlane16_swap_b32 v156, v158
    v_permlane16_swap_b32 v157, v159
    ds_write_b128 v8, v[144:147] offset:0
    ds_write_b128 v8, v[148:151] offset:1024
    ds_write_b128 v8, v[152:155] offset:2048
    ds_write_b128 v8, v[156:159] offset:3072
    s_add_u32 s58, s60, 1
    v_mov_b32 v9, s58
    ds_write_b32 v0, v9 offset:17408
    v_mfma_f32_32x32x16_bf16 v[176:191], v[208:211], v[144:147], v[240:255]
    v_mfma_f32_32x32x16_bf16 v[176:191], v[212:215], v[148:151], v[176:191]
    s_nop 11
    s_getreg_b32 s58, hwreg(HW_REG_IB_STS, 0, 4)
    s_or_b32 s58, s58, s74
    s_cmp_eq_u32 s58, 0
    s_cbranch_scc1 Ltg_5
Ltb_6:
    v_exp_f32 v176, v176
    v_exp_f32 v177, v177
    v_exp_f32 v178, v178
    v_exp_f32 v179, v179
    v_exp_f32 v180, v180
    v_exp_f32 v181, v181
    v_exp_f32 v182, v182
    v_exp_f32 v183, v183
    v_mfma_f32_32x32x16_bf16 v[192:207], v[208:211], v[152:155], 0
    v_cvt_pk_bf16_f32 v96, v176, v177
    v_cvt_pk_bf16_f32 v97, v178, v179
    v_cvt_pk_bf16_f32 v98, v180, v181
    v_cvt_pk_bf16_f32 v99, v182, v183
    v_exp_f32 v184, v184
    v_mfma_f32_32x32x16_bf16 v[192:207], v[212:215], v[156:159], v[192:207]
    v_exp_f32 v185, v185
    v_exp_f32 v186, v186
    v_exp_f32 v187, v187
    v_exp_f32 v188, v188
    v_mfma_f32_32x32x16_bf16 v[16:31], v[216:219], v[96:99], 0
    v_exp_f32 v189, v189
    v_exp_f32 v190, v190
    v_exp_f32 v191, v191
    v_cvt_pk_bf16_f32 v100, v184, v185
    v_mfma_f32_16x16x32_bf16 v[80:83], v[4:7], v[96:99], 0
    v_cvt_pk_bf16_f32 v101, v186, v187
    v_cvt_pk_bf16_f32 v102, v188, v189
    v_cvt_pk_bf16_f32 v103, v190, v191
    s_getreg_b32 s58, hwreg(HW_REG_IB_STS, 0, 4)
    s_or_b32 s58, s58, s74
    s_cmp_eq_u32 s58, 0
    s_cbranch_scc1 Ltg_7
Ltb_8:
    s_add_u32 s59, s60, 1
Lw_9:
    ds_read_b32 v10, v0 offset:17416
    s_waitcnt lgkmcnt(0)
    v_cmp_ne_u32 vcc, s59, v10
    s_cbranch_vccnz Lw_9
    ds_read_b128 v[160:163], v8 offset:4096
    ds_read_b128 v[164:167], v8 offset:5120
    ds_read_b128 v[168:171], v8 offset:6144
    ds_read_b128 v[172:175], v8 offset:7168
    v_exp_f32 v192, v192
    v_exp_f32 v193, v193
    v_mfma_f32_32x32x16_bf16 v[16:31], v[220:223], v[100:103], v[16:31]
    v_exp_f32 v194, v194
    v_exp_f32 v195, v195
    v_exp_f32 v196, v196
    v_exp_f32 v197, v197
    v_mfma_f32_16x16x32_bf16 v[80:83], v[4:7], v[100:103], v[80:83]
    v_exp_f32 v198, v198
    v_exp_f32 v199, v199
    v_mfma_f32_32x32x16_bf16 v[176:191], v[224:227], v[152:155], v[240:255]
    v_cvt_pk_bf16_f32 v104, v192, v193
    v_cvt_pk_bf16_f32 v105, v194, v195
    v_cvt_pk_bf16_f32 v106, v196, v197
    v_cvt_pk_bf16_f32 v107, v198, v199
    v_exp_f32 v200, v200
    v_mfma_f32_32x32x16_bf16 v[176:191], v[228:231], v[156:159], v[176:191]
    v_exp_f32 v201, v201
    v_exp_f32 v202, v202
    v_exp_f32 v203, v203
    v_exp_f32 v204, v204
    v_mfma_f32_32x32x16_bf16 v[32:47], v[216:219], v[104:107], 0
    v_exp_f32 v205, v205
    v_exp_f32 v206, v206
    v_exp_f32 v207, v207
    v_cvt_pk_bf16_f32 v108, v200, v201
    v_mfma_f32_16x16x32_bf16 v[84:87], v[4:7], v[104:107], 0
    v_cvt_pk_bf16_f32 v109, v202, v203
    v_cvt_pk_bf16_f32 v110, v204, v205
    v_cvt_pk_bf16_f32 v111, v206, v207
    s_waitcnt lgkmcnt(0)
    ds_write_b32 v0, v9 offset:17424
    s_getreg_b32 s58, hwreg(HW_REG_IB_STS, 0, 4)
    s_or_b32 s58, s58, s74
    s_cmp_eq_u32 s58, 0
    s_cbranch_scc1 Ltg_10
Ltb_11:
    ds_read_b32 v11, v0 offset:17472
    v_exp_f32 v176, v176
    v_exp_f32 v177, v177
    v_mfma_f32_32x32x16_bf16 v[32:47], v[220:223], v[108:111], v[32:47]
    v_exp_f32 v178, v178
    v_exp_f32 v179, v179
    v_exp_f32 v180, v180
    v_exp_f32 v181, v181
    v_mfma_f32_16x16x32_bf16 v[84:87], v[4:7], v[108:111], v[84:87]
    v_exp_f32 v182, v182
    v_exp_f32 v183, v183
    v_mfma_f32_32x32x16_bf16 v[192:207], v[208:211], v[160:163], 0
    v_cvt_pk_bf16_f32 v96, v176, v177
    v_cvt_pk_bf16_f32 v97, v178, v179
    v_cvt_pk_bf16_f32 v98, v180, v181
    v_cvt_pk_bf16_f32 v99, v182, v183
    v_exp_f32 v184, v184
    v_mfma_f32_32x32x16_bf16 v[192:207], v[212:215], v[164:167], v[192:207]
    v_exp_f32 v185, v185
    v_exp_f32 v186, v186
    v_exp_f32 v187, v187
    v_exp_f32 v188, v188
    v_mfma_f32_32x32x16_bf16 v[32:47], v[232:235], v[96:99], v[32:47]
    v_exp_f32 v189, v189
    v_exp_f32 v190, v190
    v_exp_f32 v191, v191
    v_cvt_pk_bf16_f32 v100, v184, v185
    v_mfma_f32_16x16x32_bf16 v[84:87], v[4:7], v[96:99], v[84:87]
    v_cvt_pk_bf16_f32 v101, v186, v187
    v_cvt_pk_bf16_f32 v102, v188, v189
    v_cvt_pk_bf16_f32 v103, v190, v191
    s_getreg_b32 s58, hwreg(HW_REG_IB_STS, 0, 4)
    s_or_b32 s58, s58, s74
    s_cmp_eq_u32 s58, 0
    s_cbranch_scc1 Ltg_12
Ltb_13:
    s_waitcnt lgkmcnt(0)
    v_cmp_ne_u32 vcc, v9, v11
    s_or_b32 s58, vcc_lo, s76
    s_cmp_eq_u32 s58, 0
    s_cbranch_scc1 Lrg_14
Lrb_15:
    ds_read_b32 v11, v0 offset:17472
    v_exp_f32 v192, v192
    v_exp_f32 v193, v193
    v_mfma_f32_32x32x16_bf16 v[32:47], v[236:239], v[100:103], v[32:47]
    v_exp_f32 v194, v194
    v_exp_f32 v195, v195
    v_exp_f32 v196, v196
    v_exp_f32 v197, v197
    v_mfma_f32_16x16x32_bf16 v[84:87], v[4:7], v[100:103], v[84:87]
    v_exp_f32 v198, v198
    v_exp_f32 v199, v199
    v_mfma_f32_32x32x16_bf16 v[176:191], v[208:211], v[168:171], 0
    v_cvt_pk_bf16_f32 v104, v192, v193
    v_cvt_pk_bf16_f32 v105, v194, v195
    v_cvt_pk_bf16_f32 v106, v196, v197
    v_cvt_pk_bf16_f32 v107, v198, v199
    v_exp_f32 v200, v200
    v_mfma_f32_32x32x16_bf16 v[176:191], v[212:215], v[172:175], v[176:191]
    v_exp_f32 v201, v201
    v_exp_f32 v202, v202
    v_exp_f32 v203, v203
    v_exp_f32 v204, v204
    v_mfma_f32_32x32x16_bf16 v[48:63], v[216:219], v[104:107], 0
    v_exp_f32 v205, v205
    v_exp_f32 v206, v206
    v_exp_f32 v207, v207
    v_cvt_pk_bf16_f32 v108, v200, v201
    v_mfma_f32_16x16x32_bf16 v[88:91], v[4:7], v[104:107], 0
    v_cvt_pk_bf16_f32 v109, v202, v203
    v_cvt_pk_bf16_f32 v110, v204, v205
    v_cvt_pk_bf16_f32 v111, v206, v207
    s_waitcnt lgkmcnt(0)
    v_cmp_ne_u32 vcc, v9, v11
    s_or_b32 s58, vcc_lo, s76
    s_cmp_eq_u32 s58, 0
    s_cbranch_scc1 Lrg_16
Lrb_17:
    ds_read_b32 v11, v0 offset:17472
    v_exp_f32 v176, v176
    v_exp_f32 v177, v177
    v_mfma_f32_32x32x16_bf16 v[48:63], v[220:223], v[108:111], v[48:63]
    v_exp_f32 v178, v178
    v_exp_f32 v179, v179
    v_exp_f32 v180, v180
    v_exp_f32 v181, v181
    v_mfma_f32_16x16x32_bf16 v[88:91], v[4:7], v[108:111], v[88:91]
    v_exp_f32 v182, v182
    v_exp_f32 v183, v183
    v_mfma_f32_32x32x16_bf16 v[192:207], v[224:227], v[160:163], 0
    v_cvt_pk_bf16_f32 v96, v176, v177
    v_cvt_pk_bf16_f32 v97, v178, v179
    v_cvt_pk_bf16_f32 v98, v180, v181
    v_cvt_pk_bf16_f32 v99, v182, v183
    v_exp_f32 v184, v184
    v_mfma_f32_32x32x16_bf16 v[192:207], v[228:231], v[164:167], v[192:207]
    v_exp_f32 v185, v185
    v_exp_f32 v186, v186
    v_exp_f32 v187, v187
    v_exp_f32 v188, v188
    v_mfma_f32_32x32x16_bf16 v[64:79], v[216:219], v[96:99], 0
    v_exp_f32 v189, v189
    v_exp_f32 v190, v190
    v_exp_f32 v191, v191
    v_cvt_pk_bf16_f32 v100, v184, v185
    v_mfma_f32_16x16x32_bf16 v[92:95], v[4:7], v[96:99], 0
    v_cvt_pk_bf16_f32 v101, v186, v187
    v_cvt_pk_bf16_f32 v102, v188, v189
    v_cvt_pk_bf16_f32 v103, v190, v191
    s_waitcnt lgkmcnt(0)
    v_cmp_ne_u32 vcc, v9, v11
    s_or_b32 s58, vcc_lo, s76
    s_cmp_eq_u32 s58, 0
    s_cbranch_scc1 Lrg_18
Lrb_19:
    v_exp_f32 v192, v192
    v_exp_f32 v193, v193
    v_mfma_f32_32x32x16_bf16 v[64:79], v[220:223], v[100:103], v[64:79]
    v_exp_f32 v194, v194
    v_exp_f32 v195, v195
    v_exp_f32 v196, v196
    v_exp_f32 v197, v197
    v_mfma_f32_16x16x32_bf16 v[92:95], v[4:7], v[100:103], v[92:95]
    v_exp_f32 v198, v198
    v_exp_f32 v199, v199
    v_mfma_f32_32x32x16_bf16 v[176:191], v[224:227], v[168:171], 0
    v_cvt_pk_bf16_f32 v104, v192, v193
    v_cvt_pk_bf16_f32 v105, v194, v195
    v_cvt_pk_bf16_f32 v106, v196, v197
    v_cvt_pk_bf16_f32 v107, v198, v199
    v_exp_f32 v200, v200
    v_mfma_f32_32x32x16_bf16 v[176:191], v[228:231], v[172:175], v[176:191]
    v_exp_f32 v201, v201
    v_exp_f32 v202, v202
    v_exp_f32 v203, v203
    v_exp_f32 v204, v204
    v_mfma_f32_32x32x16_bf16 v[48:63], v[232:235], v[104:107], v[48:63]
    v_exp_f32 v205, v205
    v_exp_f32 v206, v206
    v_exp_f32 v207, v207
    v_cvt_pk_bf16_f32 v108, v200, v201
    v_mfma_f32_16x16x32_bf16 v[88:91], v[4:7], v[104:107], v[88:91]
    v_cvt_pk_bf16_f32 v109, v202, v203
    v_cvt_pk_bf16_f32 v110, v204, v205
    v_cvt_pk_bf16_f32 v111, v206, v207
    s_cmp_eq_u32 s74, 0
    s_cbranch_scc1 Ltg_20
Ltb_21:
    s_cmp_eq_u32 s76, 0
    s_cbranch_scc1 Lrg_22
Lrb_23:
    s_cmp_ge_u32 s40, 1
    s_cselect_b32 s56, -1, 0
    s_cmp_ge_u32 s40, 2
    s_cselect_b32 s57, -1, 0
    v_and_b32 v8, s56, v4
    v_and_b32 v9, s56, v4
    v_and_b32 v10, s56, v4
    v_and_b32 v11, s56, v4
    v_and_b32 v12, s57, v4
    v_and_b32 v13, s57, v4
    v_and_b32 v14, s57, v4
    v_and_b32 v15, s57, v4
    v_exp_f32 v176, v176
    v_exp_f32 v177, v177
    v_mfma_f32_32x32x16_bf16 v[48:63], v[236:239], v[108:111], v[48:63]
    v_exp_f32 v178, v178
    v_exp_f32 v179, v179
    v_exp_f32 v180, v180
    v_exp_f32 v181, v181
    v_mfma_f32_16x16x32_bf16 v[88:91], v[4:7], v[108:111], v[88:91]
    v_exp_f32 v182, v182
    v_exp_f32 v183, v183
    s_waitcnt vmcnt(4)
    v_mfma_f32_32x32x16_bf16 v[192:207], v[112:115], v[168:171], 0
    v_cvt_pk_bf16_f32 v96, v176, v177
    v_cvt_pk_bf16_f32 v97, v178, v179
    v_cvt_pk_bf16_f32 v98, v180, v181
    v_cvt_pk_bf16_f32 v99, v182, v183
    v_exp_f32 v184, v184
    v_mfma_f32_32x32x16_bf16 v[192:207], v[116:119], v[172:175], v[192:207]
    v_exp_f32 v185, v185
    v_exp_f32 v186, v186
    v_exp_f32 v187, v187
    v_exp_f32 v188, v188
    v_mfma_f32_32x32x16_bf16 v[64:79], v[232:235], v[96:99], v[64:79]
    v_exp_f32 v189, v189
    v_exp_f32 v190, v190
    v_exp_f32 v191, v191
    v_cvt_pk_bf16_f32 v100, v184, v185
    v_mfma_f32_16x16x32_bf16 v[92:95], v[4:7], v[96:99], v[92:95]
    v_cvt_pk_bf16_f32 v101, v186, v187
    v_cvt_pk_bf16_f32 v102, v188, v189
    v_cvt_pk_bf16_f32 v103, v190, v191
    ds_read_b128 v[240:243], v3 offset:18432
    ds_read_b128 v[244:247], v3 offset:19456
    ds_read_b128 v[248:251], v3 offset:20480
    ds_read_b128 v[252:255], v3 offset:21504
    v_exp_f32 v192, v192
    v_exp_f32 v193, v193
    v_mfma_f32_32x32x16_bf16 v[64:79], v[236:239], v[100:103], v[64:79]
    v_exp_f32 v194, v194
    v_exp_f32 v195, v195
    v_exp_f32 v196, v196
    v_exp_f32 v197, v197
    v_mfma_f32_16x16x32_bf16 v[92:95], v[4:7], v[100:103], v[92:95]
    v_exp_f32 v198, v198
    v_exp_f32 v199, v199
    s_waitcnt vmcnt(0)
    v_mfma_f32_32x32x16_bf16 v[176:191], v[128:131], v[168:171], 0
    v_cvt_pk_bf16_f32 v104, v192, v193
    v_cvt_pk_bf16_f32 v105, v194, v195
    v_cvt_pk_bf16_f32 v106, v196, v197
    v_cvt_pk_bf16_f32 v107, v198, v199
    v_exp_f32 v200, v200
    v_mfma_f32_32x32x16_bf16 v[176:191], v[132:135], v[172:175], v[176:191]
    v_exp_f32 v201, v201
    v_exp_f32 v202, v202
    v_exp_f32 v203, v203
    v_exp_f32 v204, v204
    v_mfma_f32_32x32x16_bf16 v[64:79], v[120:123], v[104:107], v[64:79]
    v_exp_f32 v205, v205
    v_exp_f32 v206, v206
    v_exp_f32 v207, v207
    v_cvt_pk_bf16_f32 v108, v200, v201
    v_mfma_f32_16x16x32_bf16 v[92:95], v[8:11], v[104:107], v[92:95]
    v_cvt_pk_bf16_f32 v109, v202, v203
    v_cvt_pk_bf16_f32 v110, v204, v205
    v_cvt_pk_bf16_f32 v111, v206, v207
    buffer_load_dwordx4 v[208:211], v3, s[32:35], s69 offen offset:0 sc1
    buffer_load_dwordx4 v[212:215], v3, s[32:35], s69 offen offset:1024 sc1
    buffer_load_dwordx4 v[216:219], v3, s[32:35], s69 offen offset:2048 sc1
    buffer_load_dwordx4 v[220:223], v3, s[32:35], s69 offen offset:3072 sc1
    s_add_u32 s58, s69, 4096
    buffer_load_dwordx4 v[224:227], v3, s[32:35], s58 offen offset:0 sc1
    buffer_load_dwordx4 v[228:231], v3, s[32:35], s58 offen offset:1024 sc1
    buffer_load_dwordx4 v[232:235], v3, s[32:35], s58 offen offset:2048 sc1
    buffer_load_dwordx4 v[236:239], v3, s[32:35], s58 offen offset:3072 sc1
    s_add_u32 s58, s60, 1
    v_mov_b32 v1, s58
    ds_write_b32 v0, v1 offset:17536
    s_lshl_b32 s58, s44, 13
    v_add_u32 v4, s58, v3
    s_lshl_b32 s58, s44, 9
    v_lshlrev_b32 v5, 2, v2
    v_add_u32 v5, s58, v5
    v_and_b32 v6, 15, v2
    v_lshlrev_b32 v6, 4, v6
    v_bfe_u32 v7, v2, 4, 1
    v_lshl_add_u32 v6, v7, 10, v6
    v_cmp_ne_u32 s[72:73], 0, v7
    v_lshrrev_b32 v7, 5, v2
    v_lshl_add_u32 v6, v7, 8, v6
    v_exp_f32 v176, v176
    v_exp_f32 v177, v177
    v_mfma_f32_32x32x16_bf16 v[64:79], v[124:127], v[108:111], v[64:79]
    v_exp_f32 v178, v178
    v_exp_f32 v179, v179
    v_exp_f32 v180, v180
    v_exp_f32 v181, v181
    v_mfma_f32_16x16x32_bf16 v[92:95], v[8:11], v[108:111], v[92:95]
    v_exp_f32 v182, v182
    v_exp_f32 v183, v183
    v_mfma_f32_32x32x16_bf16 v[192:207], v[112:115], v[160:163], 0
    v_cvt_pk_bf16_f32 v96, v176, v177
    v_cvt_pk_bf16_f32 v97, v178, v179
    v_cvt_pk_bf16_f32 v98, v180, v181
    v_cvt_pk_bf16_f32 v99, v182, v183
    v_exp_f32 v184, v184
    v_mfma_f32_32x32x16_bf16 v[192:207], v[116:119], v[164:167], v[192:207]
    v_exp_f32 v185, v185
    v_exp_f32 v186, v186
    v_exp_f32 v187, v187
    v_exp_f32 v188, v188
    v_mfma_f32_32x32x16_bf16 v[64:79], v[136:139], v[96:99], v[64:79]
    v_exp_f32 v189, v189
    v_exp_f32 v190, v190
    v_exp_f32 v191, v191
    v_cvt_pk_bf16_f32 v100, v184, v185
    v_mfma_f32_16x16x32_bf16 v[92:95], v[8:11], v[96:99], v[92:95]
    v_cvt_pk_bf16_f32 v101, v186, v187
    v_cvt_pk_bf16_f32 v102, v188, v189
    v_cvt_pk_bf16_f32 v103, v190, v191
    ds_read_b32 v1, v0 offset:17432
    v_exp_f32 v192, v192
    v_exp_f32 v193, v193
    v_mfma_f32_32x32x16_bf16 v[64:79], v[140:143], v[100:103], v[64:79]
    v_exp_f32 v194, v194
    v_exp_f32 v195, v195
    v_exp_f32 v196, v196
    v_exp_f32 v197, v197
    v_mfma_f32_16x16x32_bf16 v[92:95], v[8:11], v[100:103], v[92:95]
    v_exp_f32 v198, v198
    v_exp_f32 v199, v199
    v_mfma_f32_32x32x16_bf16 v[176:191], v[128:131], v[160:163], 0
    v_cvt_pk_bf16_f32 v104, v192, v193
    v_cvt_pk_bf16_f32 v105, v194, v195
    v_cvt_pk_bf16_f32 v106, v196, v197
    v_cvt_pk_bf16_f32 v107, v198, v199
    v_exp_f32 v200, v200
    v_mfma_f32_32x32x16_bf16 v[176:191], v[132:135], v[164:167], v[176:191]
    v_exp_f32 v201, v201
    v_exp_f32 v202, v202
    v_exp_f32 v203, v203
    v_exp_f32 v204, v204
    v_mfma_f32_32x32x16_bf16 v[48:63], v[120:123], v[104:107], v[48:63]
    v_exp_f32 v205, v205
    v_exp_f32 v206, v206
    v_exp_f32 v207, v207
    v_cvt_pk_bf16_f32 v108, v200, v201
    v_mfma_f32_16x16x32_bf16 v[88:91], v[8:11], v[104:107], v[88:91]
    v_cvt_pk_bf16_f32 v109, v202, v203
    v_cvt_pk_bf16_f32 v110, v204, v205
    v_cvt_pk_bf16_f32 v111, v206, v207
    s_add_u32 s59, s60, 1
    s_waitcnt lgkmcnt(0)
    v_cmp_ne_u32 vcc, s59, v1
    s_cbranch_vccnz Lcg_24
Lcb_25:
    v_cndmask_b32 v7, v92, v93, s[72:73]
    ds_write_b128 v4, v[64:67] offset:0
    ds_write_b128 v4, v[68:71] offset:1024
    ds_write_b128 v4, v[72:75] offset:2048
    ds_write_b128 v4, v[76:79] offset:3072
    ds_write_b32 v5, v7 offset:16384
    s_add_u32 s58, s60, 1
    v_mov_b32 v1, s58
    ds_write_b32 v0, v1 offset:17440
    v_exp_f32 v176, v176
    v_exp_f32 v177, v177
    v_mfma_f32_32x32x16_bf16 v[48:63], v[124:127], v[108:111], v[48:63]
    v_exp_f32 v178, v178
    v_exp_f32 v179, v179
    v_exp_f32 v180, v180
    v_exp_f32 v181, v181
    v_mfma_f32_16x16x32_bf16 v[88:91], v[8:11], v[108:111], v[88:91]
    v_exp_f32 v182, v182
    v_exp_f32 v183, v183
    v_mfma_f32_32x32x16_bf16 v[192:207], v[112:115], v[144:147], 0
    v_cvt_pk_bf16_f32 v96, v176, v177
    v_cvt_pk_bf16_f32 v97, v178, v179
    v_cvt_pk_bf16_f32 v98, v180, v181
    v_cvt_pk_bf16_f32 v99, v182, v183
    v_exp_f32 v184, v184
    v_mfma_f32_32x32x16_bf16 v[192:207], v[116:119], v[148:151], v[192:207]
    v_exp_f32 v185, v185
    v_exp_f32 v186, v186
    v_exp_f32 v187, v187
    v_exp_f32 v188, v188
    v_mfma_f32_32x32x16_bf16 v[48:63], v[136:139], v[96:99], v[48:63]
    v_exp_f32 v189, v189
    v_exp_f32 v190, v190
    v_exp_f32 v191, v191
    v_cvt_pk_bf16_f32 v100, v184, v185
    v_mfma_f32_16x16x32_bf16 v[88:91], v[8:11], v[96:99], v[88:91]
    v_cvt_pk_bf16_f32 v101, v186, v187
    v_cvt_pk_bf16_f32 v102, v188, v189
    v_cvt_pk_bf16_f32 v103, v190, v191
    ds_read_b32 v1, v0 offset:17448
    v_exp_f32 v192, v192
    v_exp_f32 v193, v193
    v_mfma_f32_32x32x16_bf16 v[48:63], v[140:143], v[100:103], v[48:63]
    v_exp_f32 v194, v194
    v_exp_f32 v195, v195
    v_exp_f32 v196, v196
    v_exp_f32 v197, v197
    v_mfma_f32_16x16x32_bf16 v[88:91], v[8:11], v[100:103], v[88:91]
    v_exp_f32 v198, v198
    v_exp_f32 v199, v199
    v_mfma_f32_32x32x16_bf16 v[176:191], v[128:131], v[144:147], 0
    v_cvt_pk_bf16_f32 v104, v192, v193
    v_cvt_pk_bf16_f32 v105, v194, v195
    v_cvt_pk_bf16_f32 v106, v196, v197
    v_cvt_pk_bf16_f32 v107, v198, v199
    v_exp_f32 v200, v200
    v_mfma_f32_32x32x16_bf16 v[176:191], v[132:135], v[148:151], v[176:191]
    v_exp_f32 v201, v201
    v_exp_f32 v202, v202
    v_exp_f32 v203, v203
    v_exp_f32 v204, v204
    v_mfma_f32_32x32x16_bf16 v[16:31], v[120:123], v[104:107], v[16:31]
    v_exp_f32 v205, v205
    v_exp_f32 v206, v206
    v_exp_f32 v207, v207
    v_cvt_pk_bf16_f32 v108, v200, v201
    v_mfma_f32_16x16x32_bf16 v[80:83], v[8:11], v[104:107], v[80:83]
    v_cvt_pk_bf16_f32 v109, v202, v203
    v_cvt_pk_bf16_f32 v110, v204, v205
    v_cvt_pk_bf16_f32 v111, v206, v207
    s_add_u32 s59, s60, 1
    s_waitcnt lgkmcnt(0)
    v_cmp_ne_u32 vcc, s59, v1
    s_cbranch_vccnz Lcg_26
Lcb_27:
    ds_read_b128 v[64:67], v4 offset:4096
    ds_read_b128 v[68:71], v4 offset:5120
    ds_read_b128 v[72:75], v4 offset:6144
    ds_read_b128 v[76:79], v4 offset:7168
    ds_read_b32 v92, v5 offset:16640
    v_exp_f32 v176, v176
    v_exp_f32 v177, v177
    v_mfma_f32_32x32x16_bf16 v[16:31], v[124:127], v[108:111], v[16:31]
    v_exp_f32 v178, v178
    v_exp_f32 v179, v179
    v_exp_f32 v180, v180
    v_exp_f32 v181, v181
    v_mfma_f32_16x16x32_bf16 v[80:83], v[8:11], v[108:111], v[80:83]
    v_exp_f32 v182, v182
    v_exp_f32 v183, v183
    s_waitcnt vmcnt(4) lgkmcnt(0)
    v_mfma_f32_32x32x16_bf16 v[192:207], v[208:211], v[144:147], v[240:255]
    v_cvt_pk_bf16_f32 v96, v176, v177
    v_cvt_pk_bf16_f32 v97, v178, v179
    v_cvt_pk_bf16_f32 v98, v180, v181
    v_cvt_pk_bf16_f32 v99, v182, v183
    v_exp_f32 v184, v184
    v_mfma_f32_32x32x16_bf16 v[192:207], v[212:215], v[148:151], v[192:207]
    v_exp_f32 v185, v185
    v_exp_f32 v186, v186
    v_exp_f32 v187, v187
    v_exp_f32 v188, v188
    v_mfma_f32_32x32x16_bf16 v[16:31], v[136:139], v[96:99], v[16:31]
    v_exp_f32 v189, v189
    v_exp_f32 v190, v190
    v_exp_f32 v191, v191
    v_cvt_pk_bf16_f32 v100, v184, v185
    v_mfma_f32_16x16x32_bf16 v[80:83], v[8:11], v[96:99], v[80:83]
    v_cvt_pk_bf16_f32 v101, v186, v187
    v_cvt_pk_bf16_f32 v102, v188, v189
    v_cvt_pk_bf16_f32 v103, v190, v191
    v_cndmask_b32 v93, v88, v89, s[72:73]
    s_add_u32 s58, s60, 1
    v_mov_b32 v1, s58
    s_waitcnt lgkmcnt(0)
    ds_write_b32 v0, v1 offset:17456
    ds_write_b32 v0, v1 offset:17600
    v_add_f32 v93, v93, v92
    v_rcp_f32 v94, v93
    v_pk_add_f32 v[48:49], v[48:49], v[64:65]
    v_pk_add_f32 v[50:51], v[50:51], v[66:67]
    v_pk_add_f32 v[52:53], v[52:53], v[68:69]
    v_pk_add_f32 v[54:55], v[54:55], v[70:71]
    v_pk_add_f32 v[56:57], v[56:57], v[72:73]
    v_pk_add_f32 v[58:59], v[58:59], v[74:75]
    v_pk_add_f32 v[60:61], v[60:61], v[76:77]
    v_pk_add_f32 v[62:63], v[62:63], v[78:79]
    v_pk_mul_f32 v[64:65], v[48:49], v[94:95] op_sel_hi:[1,0]
    v_pk_mul_f32 v[66:67], v[50:51], v[94:95] op_sel_hi:[1,0]
    v_pk_mul_f32 v[68:69], v[52:53], v[94:95] op_sel_hi:[1,0]
    v_pk_mul_f32 v[70:71], v[54:55], v[94:95] op_sel_hi:[1,0]
    v_pk_mul_f32 v[72:73], v[56:57], v[94:95] op_sel_hi:[1,0]
    v_pk_mul_f32 v[74:75], v[58:59], v[94:95] op_sel_hi:[1,0]
    v_pk_mul_f32 v[76:77], v[60:61], v[94:95] op_sel_hi:[1,0]
    v_pk_mul_f32 v[78:79], v[62:63], v[94:95] op_sel_hi:[1,0]
    v_cvt_pk_bf16_f32 v64, v64, v65
    v_cvt_pk_bf16_f32 v65, v66, v67
    v_cvt_pk_bf16_f32 v66, v68, v69
    v_cvt_pk_bf16_f32 v67, v70, v71
    v_cvt_pk_bf16_f32 v68, v72, v73
    v_cvt_pk_bf16_f32 v69, v74, v75
    v_cvt_pk_bf16_f32 v70, v76, v77
    v_cvt_pk_bf16_f32 v71, v78, v79
    s_add_u32 s58, s66, 131072
    buffer_store_dwordx4 v[64:67], v6, s[32:35], s58 offen sc1
    buffer_store_dwordx4 v[68:71], v6, s[32:35], s58 offen offset:512 sc1
    v_pk_mul_f32 v[72:73], v[48:49], 0
    v_pk_mul_f32 v[74:75], v[50:51], 0
    v_pk_fma_f32 v[72:73], v[52:53], 0, v[72:73]
    v_pk_fma_f32 v[74:75], v[54:55], 0, v[74:75]
    v_pk_fma_f32 v[72:73], v[56:57], 0, v[72:73]
    v_pk_fma_f32 v[74:75], v[58:59], 0, v[74:75]
    v_pk_fma_f32 v[72:73], v[60:61], 0, v[72:73]
    v_pk_fma_f32 v[74:75], v[62:63], 0, v[74:75]
    v_pk_add_f32 v[72:73], v[72:73], v[74:75]
    v_add_f32 v72, v72, v73
    v_add_f32 v72, v72, v93
    v_cmp_le_f32 vcc, 0x30800000, v72
    s_mov_b64 s[56:57], vcc
    v_cmp_ge_f32 vcc, 0x4e800000, v72
    s_and_b64 s[56:57], s[56:57], vcc
    s_cmp_eq_u64 s[56:57], -1
    s_cselect_b32 s75, 0, 1
    s_or_b32 s63, s63, s75
    v_exp_f32 v192, v192
    v_exp_f32 v193, v193
    v_mfma_f32_32x32x16_bf16 v[16:31], v[140:143], v[100:103], v[16:31]
    v_exp_f32 v194, v194
    v_exp_f32 v195, v195
    v_exp_f32 v196, v196
    v_exp_f32 v197, v197
    v_mfma_f32_16x16x32_bf16 v[80:83], v[8:11], v[100:103], v[80:83]
    v_exp_f32 v198, v198
    v_exp_f32 v199, v199
    s_waitcnt vmcnt(2)
    v_mfma_f32_32x32x16_bf16 v[176:191], v[224:227], v[144:147], 0
    v_cvt_pk_bf16_f32 v104, v192, v193
    v_cvt_pk_bf16_f32 v105, v194, v195
    v_cvt_pk_bf16_f32 v106, v196, v197
    v_cvt_pk_bf16_f32 v107, v198, v199
    v_exp_f32 v200, v200
    v_mfma_f32_32x32x16_bf16 v[176:191], v[228:231], v[148:151], v[176:191]
    v_exp_f32 v201, v201
    v_exp_f32 v202, v202
    v_exp_f32 v203, v203
    v_exp_f32 v204, v204
    v_mfma_f32_32x32x16_bf16 v[16:31], v[216:219], v[104:107], v[16:31]
    v_exp_f32 v205, v205
    v_exp_f32 v206, v206
    v_exp_f32 v207, v207
    v_cvt_pk_bf16_f32 v108, v200, v201
    v_mfma_f32_16x16x32_bf16 v[80:83], v[12:15], v[104:107], v[80:83]
    v_cvt_pk_bf16_f32 v109, v202, v203
    v_cvt_pk_bf16_f32 v110, v204, v205
    v_cvt_pk_bf16_f32 v111, v206, v207
    v_exp_f32 v176, v176
    v_exp_f32 v177, v177
    v_mfma_f32_32x32x16_bf16 v[16:31], v[220:223], v[108:111], v[16:31]
    v_exp_f32 v178, v178
    v_exp_f32 v179, v179
    v_exp_f32 v180, v180
    v_exp_f32 v181, v181
    v_mfma_f32_16x16x32_bf16 v[80:83], v[12:15], v[108:111], v[80:83]
    v_exp_f32 v182, v182
    v_exp_f32 v183, v183
    v_mfma_f32_32x32x16_bf16 v[192:207], v[112:115], v[152:155], 0
    v_cvt_pk_bf16_f32 v96, v176, v177
    v_cvt_pk_bf16_f32 v97, v178, v179
    v_cvt_pk_bf16_f32 v98, v180, v181
    v_cvt_pk_bf16_f32 v99, v182, v183
    v_exp_f32 v184, v184
    v_mfma_f32_32x32x16_bf16 v[192:207], v[116:119], v[156:159], v[192:207]
    v_exp_f32 v185, v185
    v_exp_f32 v186, v186
    v_exp_f32 v187, v187
    v_exp_f32 v188, v188
    v_mfma_f32_32x32x16_bf16 v[16:31], v[232:235], v[96:99], v[16:31]
    v_exp_f32 v189, v189
    v_exp_f32 v190, v190
    v_exp_f32 v191, v191
    v_cvt_pk_bf16_f32 v100, v184, v185
    v_mfma_f32_16x16x32_bf16 v[80:83], v[12:15], v[96:99], v[80:83]
    v_cvt_pk_bf16_f32 v101, v186, v187
    v_cvt_pk_bf16_f32 v102, v188, v189
    v_cvt_pk_bf16_f32 v103, v190, v191
    s_getreg_b32 s58, hwreg(HW_REG_IB_STS, 0, 4)
    s_or_b32 s58, s58, s75
    s_cmp_eq_u32 s58, 0
    s_cbranch_scc1 Ltg_28
Ltb_29:
    ds_read_b32 v1, v0 offset:17464
    v_exp_f32 v192, v192
    v_exp_f32 v193, v193
    v_mfma_f32_32x32x16_bf16 v[16:31], v[236:239], v[100:103], v[16:31]
    v_exp_f32 v194, v194
    v_exp_f32 v195, v195
    v_exp_f32 v196, v196
    v_exp_f32 v197, v197
    v_mfma_f32_16x16x32_bf16 v[80:83], v[12:15], v[100:103], v[80:83]
    v_exp_f32 v198, v198
    v_exp_f32 v199, v199
    v_mfma_f32_32x32x16_bf16 v[176:191], v[128:131], v[152:155], 0
    v_cvt_pk_bf16_f32 v104, v192, v193
    v_cvt_pk_bf16_f32 v105, v194, v195
    v_cvt_pk_bf16_f32 v106, v196, v197
    v_cvt_pk_bf16_f32 v107, v198, v199
    v_exp_f32 v200, v200
    v_mfma_f32_32x32x16_bf16 v[176:191], v[132:135], v[156:159], v[176:191]
    v_exp_f32 v201, v201
    v_exp_f32 v202, v202
    v_exp_f32 v203, v203
    v_exp_f32 v204, v204
    v_mfma_f32_32x32x16_bf16 v[32:47], v[120:123], v[104:107], v[32:47]
    v_exp_f32 v205, v205
    v_exp_f32 v206, v206
    v_exp_f32 v207, v207
    v_cvt_pk_bf16_f32 v108, v200, v201
    v_mfma_f32_16x16x32_bf16 v[84:87], v[8:11], v[104:107], v[84:87]
    v_cvt_pk_bf16_f32 v109, v202, v203
    v_cvt_pk_bf16_f32 v110, v204, v205
    v_cvt_pk_bf16_f32 v111, v206, v207
    s_add_u32 s59, s60, 1
    s_waitcnt lgkmcnt(0)
    v_cmp_ne_u32 vcc, s59, v1
    s_cbranch_vccnz Lcg_30
Lcb_31:
    v_cndmask_b32 v7, v80, v81, s[72:73]
    ds_write_b128 v4, v[16:19] offset:0
    ds_write_b128 v4, v[20:23] offset:1024
    ds_write_b128 v4, v[24:27] offset:2048
    ds_write_b128 v4, v[28:31] offset:3072
    ds_write_b32 v5, v7 offset:16384
    s_add_u32 s58, s60, 2
    v_mov_b32 v1, s58
    ds_write_b32 v0, v1 offset:17440
    s_getreg_b32 s58, hwreg(HW_REG_IB_STS, 0, 4)
    s_or_b32 s58, s58, s75
    s_cmp_eq_u32 s58, 0
    s_cbranch_scc1 Ltg_32
Ltb_33:
    v_exp_f32 v176, v176
    v_exp_f32 v177, v177
    v_mfma_f32_32x32x16_bf16 v[32:47], v[124:127], v[108:111], v[32:47]
    v_exp_f32 v178, v178
    v_exp_f32 v179, v179
    v_exp_f32 v180, v180
    v_exp_f32 v181, v181
    v_mfma_f32_16x16x32_bf16 v[84:87], v[8:11], v[108:111], v[84:87]
    v_exp_f32 v182, v182
    v_exp_f32 v183, v183
    v_mfma_f32_32x32x16_bf16 v[192:207], v[224:227], v[152:155], v[240:255]
    v_cvt_pk_bf16_f32 v96, v176, v177
    v_cvt_pk_bf16_f32 v97, v178, v179
    v_cvt_pk_bf16_f32 v98, v180, v181
    v_cvt_pk_bf16_f32 v99, v182, v183
    v_exp_f32 v184, v184
    v_mfma_f32_32x32x16_bf16 v[192:207], v[228:231], v[156:159], v[192:207]
    v_exp_f32 v185, v185
    v_exp_f32 v186, v186
    v_exp_f32 v187, v187
    v_exp_f32 v188, v188
    v_mfma_f32_32x32x16_bf16 v[32:47], v[136:139], v[96:99], v[32:47]
    v_exp_f32 v189, v189
    v_exp_f32 v190, v190
    v_exp_f32 v191, v191
    v_cvt_pk_bf16_f32 v100, v184, v185
    v_mfma_f32_16x16x32_bf16 v[84:87], v[8:11], v[96:99], v[84:87]
    v_cvt_pk_bf16_f32 v101, v186, v187
    v_cvt_pk_bf16_f32 v102, v188, v189
    v_cvt_pk_bf16_f32 v103, v190, v191
    s_getreg_b32 s58, hwreg(HW_REG_IB_STS, 0, 4)
    s_or_b32 s58, s58, s75
    s_cmp_eq_u32 s58, 0
    s_cbranch_scc1 Ltg_34
Ltb_35:
    ds_read_b32 v1, v0 offset:17448
    v_exp_f32 v192, v192
    v_exp_f32 v193, v193
    v_mfma_f32_32x32x16_bf16 v[32:47], v[140:143], v[100:103], v[32:47]
    v_exp_f32 v194, v194
    v_exp_f32 v195, v195
    v_exp_f32 v196, v196
    v_exp_f32 v197, v197
    v_mfma_f32_16x16x32_bf16 v[84:87], v[8:11], v[100:103], v[84:87]
    v_exp_f32 v198, v198
    v_exp_f32 v199, v199
    v_cvt_pk_bf16_f32 v104, v192, v193
    v_cvt_pk_bf16_f32 v105, v194, v195
    v_cvt_pk_bf16_f32 v106, v196, v197
    v_cvt_pk_bf16_f32 v107, v198, v199
    v_exp_f32 v200, v200
    v_exp_f32 v201, v201
    v_exp_f32 v202, v202
    v_exp_f32 v203, v203
    v_exp_f32 v204, v204
    v_mfma_f32_32x32x16_bf16 v[32:47], v[232:235], v[104:107], v[32:47]
    v_exp_f32 v205, v205
    v_exp_f32 v206, v206
    v_exp_f32 v207, v207
    v_cvt_pk_bf16_f32 v108, v200, v201
    v_mfma_f32_16x16x32_bf16 v[84:87], v[12:15], v[104:107], v[84:87]
    v_cvt_pk_bf16_f32 v109, v202, v203
    v_cvt_pk_bf16_f32 v110, v204, v205
    v_cvt_pk_bf16_f32 v111, v206, v207
    s_nop 1
    v_mfma_f32_32x32x16_bf16 v[32:47], v[236:239], v[108:111], v[32:47]
    v_mfma_f32_16x16x32_bf16 v[84:87], v[12:15], v[108:111], v[84:87]
    s_add_u32 s59, s60, 2
    s_waitcnt lgkmcnt(0)
    v_cmp_ne_u32 vcc, s59, v1
    s_cbranch_vccnz Lcg_36
Lcb_37:
    ds_read_b128 v[16:19], v4 offset:4096
    ds_read_b128 v[20:23], v4 offset:5120
    ds_read_b128 v[24:27], v4 offset:6144
    ds_read_b128 v[28:31], v4 offset:7168
    ds_read_b32 v80, v5 offset:16640
    s_cmp_eq_u32 s75, 0
    s_cbranch_scc1 Ltg_38
Ltb_39:
    s_nop 4
    v_cndmask_b32 v81, v84, v85, s[72:73]
    s_add_u32 s58, s60, 2
    v_mov_b32 v1, s58
    s_waitcnt lgkmcnt(0)
    ds_write_b32 v0, v1 offset:17456
    v_add_f32 v81, v81, v80
    v_rcp_f32 v82, v81
    v_pk_add_f32 v[32:33], v[32:33], v[16:17]
    v_pk_add_f32 v[34:35], v[34:35], v[18:19]
    v_pk_add_f32 v[36:37], v[36:37], v[20:21]
    v_pk_add_f32 v[38:39], v[38:39], v[22:23]
    v_pk_add_f32 v[40:41], v[40:41], v[24:25]
    v_pk_add_f32 v[42:43], v[42:43], v[26:27]
    v_pk_add_f32 v[44:45], v[44:45], v[28:29]
    v_pk_add_f32 v[46:47], v[46:47], v[30:31]
    v_pk_mul_f32 v[16:17], v[32:33], v[82:83] op_sel_hi:[1,0]
    v_pk_mul_f32 v[18:19], v[34:35], v[82:83] op_sel_hi:[1,0]
    v_pk_mul_f32 v[20:21], v[36:37], v[82:83] op_sel_hi:[1,0]
    v_pk_mul_f32 v[22:23], v[38:39], v[82:83] op_sel_hi:[1,0]
    v_pk_mul_f32 v[24:25], v[40:41], v[82:83] op_sel_hi:[1,0]
    v_pk_mul_f32 v[26:27], v[42:43], v[82:83] op_sel_hi:[1,0]
    v_pk_mul_f32 v[28:29], v[44:45], v[82:83] op_sel_hi:[1,0]
    v_pk_mul_f32 v[30:31], v[46:47], v[82:83] op_sel_hi:[1,0]
    v_cvt_pk_bf16_f32 v16, v16, v17
    v_cvt_pk_bf16_f32 v17, v18, v19
    v_cvt_pk_bf16_f32 v18, v20, v21
    v_cvt_pk_bf16_f32 v19, v22, v23
    v_cvt_pk_bf16_f32 v20, v24, v25
    v_cvt_pk_bf16_f32 v21, v26, v27
    v_cvt_pk_bf16_f32 v22, v28, v29
    v_cvt_pk_bf16_f32 v23, v30, v31
    s_add_u32 s58, s66, 65536
    buffer_store_dwordx4 v[16:19], v6, s[32:35], s58 offen sc1
    buffer_store_dwordx4 v[20:23], v6, s[32:35], s58 offen offset:512 sc1
    v_pk_mul_f32 v[24:25], v[32:33], 0
    v_pk_mul_f32 v[26:27], v[34:35], 0
    v_pk_fma_f32 v[24:25], v[36:37], 0, v[24:25]
    v_pk_fma_f32 v[26:27], v[38:39], 0, v[26:27]
    v_pk_fma_f32 v[24:25], v[40:41], 0, v[24:25]
    v_pk_fma_f32 v[26:27], v[42:43], 0, v[26:27]
    v_pk_fma_f32 v[24:25], v[44:45], 0, v[24:25]
    v_pk_fma_f32 v[26:27], v[46:47], 0, v[26:27]
    v_pk_add_f32 v[24:25], v[24:25], v[26:27]
    v_add_f32 v24, v24, v25
    v_add_f32 v24, v24, v81
    v_cmp_le_f32 vcc, 0x30800000, v24
    s_mov_b64 s[56:57], vcc
    v_cmp_ge_f32 vcc, 0x4e800000, v24
    s_and_b64 s[56:57], s[56:57], vcc
    s_cmp_eq_u64 s[56:57], -1
    s_cselect_b32 s75, 0, 2
    s_or_b32 s63, s63, s75
    s_cmp_eq_u32 s75, 0
    s_cbranch_scc1 Ltg_40
Ltb_41:
    s_cmp_lg_u32 s63, 0
    s_cbranch_scc1 Lslow_42
Lslowb_43:
    s_branch L_p3
L_p1:
    s_getreg_b32 s58, hwreg(HW_REG_IB_STS, 0, 4)
    s_or_b32 s58, s58, s74
    s_cmp_eq_u32 s58, 0
    s_cbranch_scc1 Ltg_44
Ltb_45:
    s_mov_b32 s56, 0x3e8293ee
    s_mov_b32 s57, 0x3e8293ee
    v_pk_mul_f32 v[16:17], v[16:17], s[56:57]
    v_pk_mul_f32 v[18:19], v[18:19], s[56:57]
    v_pk_mul_f32 v[20:21], v[20:21], s[56:57]
    v_pk_mul_f32 v[22:23], v[22:23], s[56:57]
    v_pk_mul_f32 v[24:25], v[24:25], s[56:57]
    v_pk_mul_f32 v[26:27], v[26:27], s[56:57]
    v_pk_mul_f32 v[28:29], v[28:29], s[56:57]
    v_pk_mul_f32 v[30:31], v[30:31], s[56:57]
    v_pk_mul_f32 v[32:33], v[32:33], s[56:57]
    v_pk_mul_f32 v[34:35], v[34:35], s[56:57]
    v_pk_mul_f32 v[36:37], v[36:37], s[56:57]
    v_pk_mul_f32 v[38:39], v[38:39], s[56:57]
    v_pk_mul_f32 v[40:41], v[40:41], s[56:57]
    v_pk_mul_f32 v[42:43], v[42:43], s[56:57]
    v_pk_mul_f32 v[44:45], v[44:45], s[56:57]
    v_pk_mul_f32 v[46:47], v[46:47], s[56:57]
    v_cvt_pk_bf16_f32 v160, v16, v17
    v_cvt_pk_bf16_f32 v162, v20, v21
    v_cvt_pk_bf16_f32 v161, v18, v19
    v_cvt_pk_bf16_f32 v163, v22, v23
    v_cvt_pk_bf16_f32 v164, v32, v33
    v_cvt_pk_bf16_f32 v166, v36, v37
    v_cvt_pk_bf16_f32 v165, v34, v35
    v_cvt_pk_bf16_f32 v167, v38, v39
    v_cvt_pk_bf16_f32 v168, v24, v25
    v_cvt_pk_bf16_f32 v170, v28, v29
    v_cvt_pk_bf16_f32 v169, v26, v27
    v_cvt_pk_bf16_f32 v171, v30, v31
    v_cvt_pk_bf16_f32 v172, v40, v41
    v_cvt_pk_bf16_f32 v174, v44, v45
    v_cvt_pk_bf16_f32 v173, v42, v43
    v_cvt_pk_bf16_f32 v175, v46, v47
    s_lshl_b32 s58, s44, 13
    v_add_u32 v8, s58, v3
    v_permlane16_swap_b32 v160, v162
    v_permlane16_swap_b32 v161, v163
    v_permlane16_swap_b32 v164, v166
    v_permlane16_swap_b32 v165, v167
    v_permlane16_swap_b32 v168, v170
    v_permlane16_swap_b32 v169, v171
    v_permlane16_swap_b32 v172, v174
    v_permlane16_swap_b32 v173, v175
    ds_write_b128 v8, v[160:163] offset:4096
    ds_write_b128 v8, v[164:167] offset:5120
    ds_write_b128 v8, v[168:171] offset:6144
    ds_write_b128 v8, v[172:175] offset:7168
    s_add_u32 s58, s60, 1
    v_mov_b32 v9, s58
    ds_write_b32 v0, v9 offset:17416
    v_mfma_f32_32x32x16_bf16 v[176:191], v[208:211], v[160:163], v[240:255]
    v_mfma_f32_32x32x16_bf16 v[176:191], v[212:215], v[164:167], v[176:191]
    s_nop 11
    s_getreg_b32 s58, hwreg(HW_REG_IB_STS, 0, 4)
    s_or_b32 s58, s58, s74
    s_cmp_eq_u32 s58, 0
    s_cbranch_scc1 Ltg_46
Ltb_47:
    v_exp_f32 v176, v176
    v_exp_f32 v177, v177
    v_exp_f32 v178, v178
    v_exp_f32 v179, v179
    v_exp_f32 v180, v180
    v_exp_f32 v181, v181
    v_exp_f32 v182, v182
    v_exp_f32 v183, v183
    v_mfma_f32_32x32x16_bf16 v[192:207], v[208:211], v[168:171], 0
    v_cvt_pk_bf16_f32 v96, v176, v177
    v_cvt_pk_bf16_f32 v97, v178, v179
    v_cvt_pk_bf16_f32 v98, v180, v181
    v_cvt_pk_bf16_f32 v99, v182, v183
    v_exp_f32 v184, v184
    v_mfma_f32_32x32x16_bf16 v[192:207], v[212:215], v[172:175], v[192:207]
    v_exp_f32 v185, v185
    v_exp_f32 v186, v186
    v_exp_f32 v187, v187
    v_exp_f32 v188, v188
    v_mfma_f32_32x32x16_bf16 v[48:63], v[216:219], v[96:99], 0
    v_exp_f32 v189, v189
    v_exp_f32 v190, v190
    v_exp_f32 v191, v191
    v_cvt_pk_bf16_f32 v100, v184, v185
    v_mfma_f32_16x16x32_bf16 v[88:91], v[4:7], v[96:99], 0
    v_cvt_pk_bf16_f32 v101, v186, v187
    v_cvt_pk_bf16_f32 v102, v188, v189
    v_cvt_pk_bf16_f32 v103, v190, v191
    s_getreg_b32 s58, hwreg(HW_REG_IB_STS, 0, 4)
    s_or_b32 s58, s58, s74
    s_cmp_eq_u32 s58, 0
    s_cbranch_scc1 Ltg_48
Ltb_49:
    s_add_u32 s59, s60, 1
Lw_50:
    ds_read_b32 v10, v0 offset:17408
    s_waitcnt lgkmcnt(0)
    v_cmp_ne_u32 vcc, s59, v10
    s_cbranch_vccnz Lw_50
    ds_read_b128 v[144:147], v8 offset:0
    ds_read_b128 v[148:151], v8 offset:1024
    ds_read_b128 v[152:155], v8 offset:2048
    ds_read_b128 v[156:159], v8 offset:3072
    v_exp_f32 v192, v192
    v_exp_f32 v193, v193
    v_mfma_f32_32x32x16_bf16 v[48:63], v[220:223], v[100:103], v[48:63]
    v_exp_f32 v194, v194
    v_exp_f32 v195, v195
    v_exp_f32 v196, v196
    v_exp_f32 v197, v197
    v_mfma_f32_16x16x32_bf16 v[88:91], v[4:7], v[100:103], v[88:91]
    v_exp_f32 v198, v198
    v_exp_f32 v199, v199
    v_mfma_f32_32x32x16_bf16 v[176:191], v[224:227], v[168:171], v[240:255]
    v_cvt_pk_bf16_f32 v104, v192, v193
    v_cvt_pk_bf16_f32 v105, v194, v195
    v_cvt_pk_bf16_f32 v106, v196, v197
    v_cvt_pk_bf16_f32 v107, v198, v199
    v_exp_f32 v200, v200
    v_mfma_f32_32x32x16_bf16 v[176:191], v[228:231], v[172:175], v[176:191]
    v_exp_f32 v201, v201
    v_exp_f32 v202, v202
    v_exp_f32 v203, v203
    v_exp_f32 v204, v204
    v_mfma_f32_32x32x16_bf16 v[64:79], v[216:219], v[104:107], 0
    v_exp_f32 v205, v205
    v_exp_f32 v206, v206
    v_exp_f32 v207, v207
    v_cvt_pk_bf16_f32 v108, v200, v201
    v_mfma_f32_16x16x32_bf16 v[92:95], v[4:7], v[104:107], 0
    v_cvt_pk_bf16_f32 v109, v202, v203
    v_cvt_pk_bf16_f32 v110, v204, v205
    v_cvt_pk_bf16_f32 v111, v206, v207
    s_waitcnt lgkmcnt(0)
    ds_write_b32 v0, v9 offset:17432
    s_getreg_b32 s58, hwreg(HW_REG_IB_STS, 0, 4)
    s_or_b32 s58, s58, s74
    s_cmp_eq_u32 s58, 0
    s_cbranch_scc1 Ltg_51
Ltb_52:
    v_exp_f32 v176, v176
    v_exp_f32 v177, v177
    v_mfma_f32_32x32x16_bf16 v[64:79], v[220:223], v[108:111], v[64:79]
    v_exp_f32 v178, v178
    v_exp_f32 v179, v179
    v_exp_f32 v180, v180
    v_exp_f32 v181, v181
    v_mfma_f32_16x16x32_bf16 v[92:95], v[4:7], v[108:111], v[92:95]
    v_exp_f32 v182, v182
    v_exp_f32 v183, v183
    v_cvt_pk_bf16_f32 v96, v176, v177
    v_cvt_pk_bf16_f32 v97, v178, v179
    v_cvt_pk_bf16_f32 v98, v180, v181
    v_cvt_pk_bf16_f32 v99, v182, v183
    v_exp_f32 v184, v184
    v_exp_f32 v185, v185
    v_exp_f32 v186, v186
    v_exp_f32 v187, v187
    v_exp_f32 v188, v188
    v_mfma_f32_32x32x16_bf16 v[64:79], v[232:235], v[96:99], v[64:79]
    v_exp_f32 v189, v189
    v_exp_f32 v190, v190
    v_exp_f32 v191, v191
    v_cvt_pk_bf16_f32 v100, v184, v185
    v_mfma_f32_16x16x32_bf16 v[92:95], v[4:7], v[96:99], v[92:95]
    v_cvt_pk_bf16_f32 v101, v186, v187
    v_cvt_pk_bf16_f32 v102, v188, v189
    v_cvt_pk_bf16_f32 v103, v190, v191
    s_nop 1
    v_mfma_f32_32x32x16_bf16 v[64:79], v[236:239], v[100:103], v[64:79]
    v_mfma_f32_16x16x32_bf16 v[92:95], v[4:7], v[100:103], v[92:95]
    s_cmp_eq_u32 s74, 0
    s_cbranch_scc1 Ltg_53
Ltb_54:
    s_add_u32 s59, s60, 1
Lw_55:
    ds_read_b32 v10, v0 offset:17424
    s_waitcnt lgkmcnt(0)
    v_cmp_ne_u32 vcc, s59, v10
    s_cbranch_vccnz Lw_55
    s_cmp_eq_u32 s76, 0
    s_cbranch_scc1 Lrg_56
Lrb_57:
    buffer_load_dwordx4 v[208:211], v3, s[32:35], s69 offen offset:0 sc1
    buffer_load_dwordx4 v[212:215], v3, s[32:35], s69 offen offset:1024 sc1
    buffer_load_dwordx4 v[216:219], v3, s[32:35], s69 offen offset:2048 sc1
    buffer_load_dwordx4 v[220:223], v3, s[32:35], s69 offen offset:3072 sc1
    s_add_u32 s58, s69, 4096
    buffer_load_dwordx4 v[224:227], v3, s[32:35], s58 offen offset:0 sc1
    buffer_load_dwordx4 v[228:231], v3, s[32:35], s58 offen offset:1024 sc1
    buffer_load_dwordx4 v[232:235], v3, s[32:35], s58 offen offset:2048 sc1
    buffer_load_dwordx4 v[236:239], v3, s[32:35], s58 offen offset:3072 sc1
    ds_read_b128 v[240:243], v3 offset:18432
    ds_read_b128 v[244:247], v3 offset:19456
    ds_read_b128 v[248:251], v3 offset:20480
    ds_read_b128 v[252:255], v3 offset:21504
    s_add_u32 s58, s60, 1
    v_mov_b32 v1, s58
    ds_write_b32 v0, v1 offset:17544
    s_cmp_ge_u32 s40, 1
    s_cselect_b32 s56, -1, 0
    s_cmp_ge_u32 s40, 2
    s_cselect_b32 s57, -1, 0
    v_and_b32 v8, s56, v4
    v_and_b32 v9, s56, v4
    v_and_b32 v10, s56, v4
    v_and_b32 v11, s56, v4
    v_and_b32 v12, s57, v4
    v_and_b32 v13, s57, v4
    v_and_b32 v14, s57, v4
    v_and_b32 v15, s57, v4
    s_lshl_b32 s58, s44, 13
    v_add_u32 v4, s58, v3
    s_lshl_b32 s58, s44, 9
    v_lshlrev_b32 v5, 2, v2
    v_add_u32 v5, s58, v5
    v_and_b32 v6, 15, v2
    v_lshlrev_b32 v6, 4, v6
    v_bfe_u32 v7, v2, 4, 1
    v_lshl_add_u32 v6, v7, 10, v6
    v_cmp_ne_u32 s[72:73], 0, v7
    v_lshrrev_b32 v7, 5, v2
    v_lshl_add_u32 v6, v7, 8, v6
    s_waitcnt vmcnt(12)
    v_mfma_f32_32x32x16_bf16 v[192:207], v[112:115], v[160:163], 0
    v_mfma_f32_32x32x16_bf16 v[192:207], v[116:119], v[164:167], v[192:207]
    s_nop 11
    v_exp_f32 v192, v192
    v_exp_f32 v193, v193
    v_exp_f32 v194, v194
    v_exp_f32 v195, v195
    v_exp_f32 v196, v196
    v_exp_f32 v197, v197
    v_exp_f32 v198, v198
    v_exp_f32 v199, v199
    s_waitcnt vmcnt(8)
    v_mfma_f32_32x32x16_bf16 v[176:191], v[128:131], v[160:163], 0
    v_cvt_pk_bf16_f32 v104, v192, v193
    v_cvt_pk_bf16_f32 v105, v194, v195
    v_cvt_pk_bf16_f32 v106, v196, v197
    v_cvt_pk_bf16_f32 v107, v198, v199
    v_exp_f32 v200, v200
    v_mfma_f32_32x32x16_bf16 v[176:191], v[132:135], v[164:167], v[176:191]
    v_exp_f32 v201, v201
    v_exp_f32 v202, v202
    v_exp_f32 v203, v203
    v_exp_f32 v204, v204
    v_mfma_f32_32x32x16_bf16 v[48:63], v[120:123], v[104:107], v[48:63]
    v_exp_f32 v205, v205
    v_exp_f32 v206, v206
    v_exp_f32 v207, v207
    v_cvt_pk_bf16_f32 v108, v200, v201
    v_mfma_f32_16x16x32_bf16 v[88:91], v[8:11], v[104:107], v[88:91]
    v_cvt_pk_bf16_f32 v109, v202, v203
    v_cvt_pk_bf16_f32 v110, v204, v205
    v_cvt_pk_bf16_f32 v111, v206, v207
    v_exp_f32 v176, v176
    v_exp_f32 v177, v177
    v_mfma_f32_32x32x16_bf16 v[48:63], v[124:127], v[108:111], v[48:63]
    v_exp_f32 v178, v178
    v_exp_f32 v179, v179
    v_exp_f32 v180, v180
    v_exp_f32 v181, v181
    v_mfma_f32_16x16x32_bf16 v[88:91], v[8:11], v[108:111], v[88:91]
    v_exp_f32 v182, v182
    v_exp_f32 v183, v183
    s_waitcnt vmcnt(4) lgkmcnt(0)
    v_mfma_f32_32x32x16_bf16 v[192:207], v[208:211], v[160:163], v[240:255]
    v_cvt_pk_bf16_f32 v96, v176, v177
    v_cvt_pk_bf16_f32 v97, v178, v179
    v_cvt_pk_bf16_f32 v98, v180, v181
    v_cvt_pk_bf16_f32 v99, v182, v183
    v_exp_f32 v184, v184
    v_mfma_f32_32x32x16_bf16 v[192:207], v[212:215], v[164:167], v[192:207]
    v_exp_f32 v185, v185
    v_exp_f32 v186, v186
    v_exp_f32 v187, v187
    v_exp_f32 v188, v188
    v_mfma_f32_32x32x16_bf16 v[48:63], v[136:139], v[96:99], v[48:63]
    v_exp_f32 v189, v189
    v_exp_f32 v190, v190
    v_exp_f32 v191, v191
    v_cvt_pk_bf16_f32 v100, v184, v185
    v_mfma_f32_16x16x32_bf16 v[88:91], v[8:11], v[96:99], v[88:91]
    v_cvt_pk_bf16_f32 v101, v186, v187
    v_cvt_pk_bf16_f32 v102, v188, v189
    v_cvt_pk_bf16_f32 v103, v190, v191
    v_exp_f32 v192, v192
    v_exp_f32 v193, v193
    v_mfma_f32_32x32x16_bf16 v[48:63], v[140:143], v[100:103], v[48:63]
    v_exp_f32 v194, v194
    v_exp_f32 v195, v195
    v_exp_f32 v196, v196
    v_exp_f32 v197, v197
    v_mfma_f32_16x16x32_bf16 v[88:91], v[8:11], v[100:103], v[88:91]
    v_exp_f32 v198, v198
    v_exp_f32 v199, v199
    s_waitcnt vmcnt(0)
    v_mfma_f32_32x32x16_bf16 v[176:191], v[224:227], v[160:163], 0
    v_cvt_pk_bf16_f32 v104, v192, v193
    v_cvt_pk_bf16_f32 v105, v194, v195
    v_cvt_pk_bf16_f32 v106, v196, v197
    v_cvt_pk_bf16_f32 v107, v198, v199
    v_exp_f32 v200, v200
    v_mfma_f32_32x32x16_bf16 v[176:191], v[228:231], v[164:167], v[176:191]
    v_exp_f32 v201, v201
    v_exp_f32 v202, v202
    v_exp_f32 v203, v203
    v_exp_f32 v204, v204
    v_mfma_f32_32x32x16_bf16 v[48:63], v[216:219], v[104:107], v[48:63]
    v_exp_f32 v205, v205
    v_exp_f32 v206, v206
    v_exp_f32 v207, v207
    v_cvt_pk_bf16_f32 v108, v200, v201
    v_mfma_f32_16x16x32_bf16 v[88:91], v[12:15], v[104:107], v[88:91]
    v_cvt_pk_bf16_f32 v109, v202, v203
    v_cvt_pk_bf16_f32 v110, v204, v205
    v_cvt_pk_bf16_f32 v111, v206, v207
    v_exp_f32 v176, v176
    v_exp_f32 v177, v177
    v_mfma_f32_32x32x16_bf16 v[48:63], v[220:223], v[108:111], v[48:63]
    v_exp_f32 v178, v178
    v_exp_f32 v179, v179
    v_exp_f32 v180, v180
    v_exp_f32 v181, v181
    v_mfma_f32_16x16x32_bf16 v[88:91], v[12:15], v[108:111], v[88:91]
    v_exp_f32 v182, v182
    v_exp_f32 v183, v183
    v_mfma_f32_32x32x16_bf16 v[192:207], v[112:115], v[168:171], 0
    v_cvt_pk_bf16_f32 v96, v176, v177
    v_cvt_pk_bf16_f32 v97, v178, v179
    v_cvt_pk_bf16_f32 v98, v180, v181
    v_cvt_pk_bf16_f32 v99, v182, v183
    v_exp_f32 v184, v184
    v_mfma_f32_32x32x16_bf16 v[192:207], v[116:119], v[172:175], v[192:207]
    v_exp_f32 v185, v185
    v_exp_f32 v186, v186
    v_exp_f32 v187, v187
    v_exp_f32 v188, v188
    v_mfma_f32_32x32x16_bf16 v[48:63], v[232:235], v[96:99], v[48:63]
    v_exp_f32 v189, v189
    v_exp_f32 v190, v190
    v_exp_f32 v191, v191
    v_cvt_pk_bf16_f32 v100, v184, v185
    v_mfma_f32_16x16x32_bf16 v[88:91], v[12:15], v[96:99], v[88:91]
    v_cvt_pk_bf16_f32 v101, v186, v187
    v_cvt_pk_bf16_f32 v102, v188, v189
    v_cvt_pk_bf16_f32 v103, v190, v191
    v_exp_f32 v192, v192
    v_exp_f32 v193, v193
    v_mfma_f32_32x32x16_bf16 v[48:63], v[236:239], v[100:103], v[48:63]
    v_exp_f32 v194, v194
    v_exp_f32 v195, v195
    v_exp_f32 v196, v196
    v_exp_f32 v197, v197
    v_mfma_f32_16x16x32_bf16 v[88:91], v[12:15], v[100:103], v[88:91]
    v_exp_f32 v198, v198
    v_exp_f32 v199, v199
    v_mfma_f32_32x32x16_bf16 v[176:191], v[128:131], v[168:171], 0
    v_cvt_pk_bf16_f32 v104, v192, v193
    v_cvt_pk_bf16_f32 v105, v194, v195
    v_cvt_pk_bf16_f32 v106, v196, v197
    v_cvt_pk_bf16_f32 v107, v198, v199
    v_exp_f32 v200, v200
    v_mfma_f32_32x32x16_bf16 v[176:191], v[132:135], v[172:175], v[176:191]
    v_exp_f32 v201, v201
    v_exp_f32 v202, v202
    v_exp_f32 v203, v203
    v_exp_f32 v204, v204
    v_mfma_f32_32x32x16_bf16 v[64:79], v[120:123], v[104:107], v[64:79]
    v_exp_f32 v205, v205
    v_exp_f32 v206, v206
    v_exp_f32 v207, v207
    v_cvt_pk_bf16_f32 v108, v200, v201
    v_mfma_f32_16x16x32_bf16 v[92:95], v[8:11], v[104:107], v[92:95]
    v_cvt_pk_bf16_f32 v109, v202, v203
    v_cvt_pk_bf16_f32 v110, v204, v205
    v_cvt_pk_bf16_f32 v111, v206, v207
    v_cndmask_b32 v7, v88, v89, s[72:73]
    ds_write_b128 v4, v[48:51] offset:4096
    ds_write_b128 v4, v[52:55] offset:5120
    ds_write_b128 v4, v[56:59] offset:6144
    ds_write_b128 v4, v[60:63] offset:7168
    ds_write_b32 v5, v7 offset:16640
    s_add_u32 s58, s60, 1
    v_mov_b32 v1, s58
    ds_write_b32 v0, v1 offset:17448
    v_exp_f32 v176, v176
    v_exp_f32 v177, v177
    v_mfma_f32_32x32x16_bf16 v[64:79], v[124:127], v[108:111], v[64:79]
    v_exp_f32 v178, v178
    v_exp_f32 v179, v179
    v_exp_f32 v180, v180
    v_exp_f32 v181, v181
    v_mfma_f32_16x16x32_bf16 v[92:95], v[8:11], v[108:111], v[92:95]
    v_exp_f32 v182, v182
    v_exp_f32 v183, v183
    v_mfma_f32_32x32x16_bf16 v[192:207], v[224:227], v[168:171], v[240:255]
    v_cvt_pk_bf16_f32 v96, v176, v177
    v_cvt_pk_bf16_f32 v97, v178, v179
    v_cvt_pk_bf16_f32 v98, v180, v181
    v_cvt_pk_bf16_f32 v99, v182, v183
    v_exp_f32 v184, v184
    v_mfma_f32_32x32x16_bf16 v[192:207], v[228:231], v[172:175], v[192:207]
    v_exp_f32 v185, v185
    v_exp_f32 v186, v186
    v_exp_f32 v187, v187
    v_exp_f32 v188, v188
    v_mfma_f32_32x32x16_bf16 v[64:79], v[136:139], v[96:99], v[64:79]
    v_exp_f32 v189, v189
    v_exp_f32 v190, v190
    v_exp_f32 v191, v191
    v_cvt_pk_bf16_f32 v100, v184, v185
    v_mfma_f32_16x16x32_bf16 v[92:95], v[8:11], v[96:99], v[92:95]
    v_cvt_pk_bf16_f32 v101, v186, v187
    v_cvt_pk_bf16_f32 v102, v188, v189
    v_cvt_pk_bf16_f32 v103, v190, v191
    ds_read_b32 v1, v0 offset:17440
    v_exp_f32 v192, v192
    v_exp_f32 v193, v193
    v_mfma_f32_32x32x16_bf16 v[64:79], v[140:143], v[100:103], v[64:79]
    v_exp_f32 v194, v194
    v_exp_f32 v195, v195
    v_exp_f32 v196, v196
    v_exp_f32 v197, v197
    v_mfma_f32_16x16x32_bf16 v[92:95], v[8:11], v[100:103], v[92:95]
    v_exp_f32 v198, v198
    v_exp_f32 v199, v199
    v_mfma_f32_32x32x16_bf16 v[176:191], v[112:115], v[152:155], 0
    v_cvt_pk_bf16_f32 v104, v192, v193
    v_cvt_pk_bf16_f32 v105, v194, v195
    v_cvt_pk_bf16_f32 v106, v196, v197
    v_cvt_pk_bf16_f32 v107, v198, v199
    v_exp_f32 v200, v200
    v_mfma_f32_32x32x16_bf16 v[176:191], v[116:119], v[156:159], v[176:191]
    v_exp_f32 v201, v201
    v_exp_f32 v202, v202
    v_exp_f32 v203, v203
    v_exp_f32 v204, v204
    v_mfma_f32_32x32x16_bf16 v[64:79], v[232:235], v[104:107], v[64:79]
    v_exp_f32 v205, v205
    v_exp_f32 v206, v206
    v_exp_f32 v207, v207
    v_cvt_pk_bf16_f32 v108, v200, v201
    v_mfma_f32_16x16x32_bf16 v[92:95], v[12:15], v[104:107], v[92:95]
    v_cvt_pk_bf16_f32 v109, v202, v203
    v_cvt_pk_bf16_f32 v110, v204, v205
    v_cvt_pk_bf16_f32 v111, v206, v207
    s_add_u32 s59, s60, 1
    s_waitcnt lgkmcnt(0)
    v_cmp_ne_u32 vcc, s59, v1
    s_cbranch_vccnz Lcg_58
Lcb_59:
    ds_read_b128 v[48:51], v4 offset:0
    ds_read_b128 v[52:55], v4 offset:1024
    ds_read_b128 v[56:59], v4 offset:2048
    ds_read_b128 v[60:63], v4 offset:3072
    ds_read_b32 v88, v5 offset:16384
    v_exp_f32 v176, v176
    v_exp_f32 v177, v177
    v_mfma_f32_32x32x16_bf16 v[64:79], v[236:239], v[108:111], v[64:79]
    v_exp_f32 v178, v178
    v_exp_f32 v179, v179
    v_exp_f32 v180, v180
    v_exp_f32 v181, v181
    v_mfma_f32_16x16x32_bf16 v[92:95], v[12:15], v[108:111], v[92:95]
    v_exp_f32 v182, v182
    v_exp_f32 v183, v183
    v_mfma_f32_32x32x16_bf16 v[192:207], v[128:131], v[152:155], 0
    v_cvt_pk_bf16_f32 v96, v176, v177
    v_cvt_pk_bf16_f32 v97, v178, v179
    v_cvt_pk_bf16_f32 v98, v180, v181
    v_cvt_pk_bf16_f32 v99, v182, v183
    v_exp_f32 v184, v184
    v_mfma_f32_32x32x16_bf16 v[192:207], v[132:135], v[156:159], v[192:207]
    v_exp_f32 v185, v185
    v_exp_f32 v186, v186
    v_exp_f32 v187, v187
    v_exp_f32 v188, v188
    v_mfma_f32_32x32x16_bf16 v[32:47], v[120:123], v[96:99], 0
    v_exp_f32 v189, v189
    v_exp_f32 v190, v190
    v_exp_f32 v191, v191
    v_cvt_pk_bf16_f32 v100, v184, v185
    v_mfma_f32_16x16x32_bf16 v[84:87], v[8:11], v[96:99], 0
    v_cvt_pk_bf16_f32 v101, v186, v187
    v_cvt_pk_bf16_f32 v102, v188, v189
    v_cvt_pk_bf16_f32 v103, v190, v191
    v_cndmask_b32 v89, v92, v93, s[72:73]
    s_add_u32 s58, s60, 1
    v_mov_b32 v1, s58
    s_waitcnt lgkmcnt(0)
    ds_write_b32 v0, v1 offset:17464
    ds_write_b32 v0, v1 offset:17608
    v_add_f32 v89, v89, v88
    v_rcp_f32 v90, v89
    v_pk_add_f32 v[64:65], v[64:65], v[48:49]
    v_pk_add_f32 v[66:67], v[66:67], v[50:51]
    v_pk_add_f32 v[68:69], v[68:69], v[52:53]
    v_pk_add_f32 v[70:71], v[70:71], v[54:55]
    v_pk_add_f32 v[72:73], v[72:73], v[56:57]
    v_pk_add_f32 v[74:75], v[74:75], v[58:59]
    v_pk_add_f32 v[76:77], v[76:77], v[60:61]
    v_pk_add_f32 v[78:79], v[78:79], v[62:63]
    v_pk_mul_f32 v[48:49], v[64:65], v[90:91] op_sel_hi:[1,0]
    v_pk_mul_f32 v[50:51], v[66:67], v[90:91] op_sel_hi:[1,0]
    v_pk_mul_f32 v[52:53], v[68:69], v[90:91] op_sel_hi:[1,0]
    v_pk_mul_f32 v[54:55], v[70:71], v[90:91] op_sel_hi:[1,0]
    v_pk_mul_f32 v[56:57], v[72:73], v[90:91] op_sel_hi:[1,0]
    v_pk_mul_f32 v[58:59], v[74:75], v[90:91] op_sel_hi:[1,0]
    v_pk_mul_f32 v[60:61], v[76:77], v[90:91] op_sel_hi:[1,0]
    v_pk_mul_f32 v[62:63], v[78:79], v[90:91] op_sel_hi:[1,0]
    v_cvt_pk_bf16_f32 v48, v48, v49
    v_cvt_pk_bf16_f32 v49, v50, v51
    v_cvt_pk_bf16_f32 v50, v52, v53
    v_cvt_pk_bf16_f32 v51, v54, v55
    v_cvt_pk_bf16_f32 v52, v56, v57
    v_cvt_pk_bf16_f32 v53, v58, v59
    v_cvt_pk_bf16_f32 v54, v60, v61
    v_cvt_pk_bf16_f32 v55, v62, v63
    s_add_u32 s58, s66, 196608
    buffer_store_dwordx4 v[48:51], v6, s[32:35], s58 offen sc1
    buffer_store_dwordx4 v[52:55], v6, s[32:35], s58 offen offset:512 sc1
    v_pk_mul_f32 v[56:57], v[64:65], 0
    v_pk_mul_f32 v[58:59], v[66:67], 0
    v_pk_fma_f32 v[56:57], v[68:69], 0, v[56:57]
    v_pk_fma_f32 v[58:59], v[70:71], 0, v[58:59]
    v_pk_fma_f32 v[56:57], v[72:73], 0, v[56:57]
    v_pk_fma_f32 v[58:59], v[74:75], 0, v[58:59]
    v_pk_fma_f32 v[56:57], v[76:77], 0, v[56:57]
    v_pk_fma_f32 v[58:59], v[78:79], 0, v[58:59]
    v_pk_add_f32 v[56:57], v[56:57], v[58:59]
    v_add_f32 v56, v56, v57
    v_add_f32 v56, v56, v89
    v_cmp_le_f32 vcc, 0x30800000, v56
    s_mov_b64 s[56:57], vcc
    v_cmp_ge_f32 vcc, 0x4e800000, v56
    s_and_b64 s[56:57], s[56:57], vcc
    s_cmp_eq_u64 s[56:57], -1
    s_cselect_b32 s75, 0, 1
    s_or_b32 s63, s63, s75
    v_exp_f32 v192, v192
    v_exp_f32 v193, v193
    v_mfma_f32_32x32x16_bf16 v[32:47], v[124:127], v[100:103], v[32:47]
    v_exp_f32 v194, v194
    v_exp_f32 v195, v195
    v_exp_f32 v196, v196
    v_exp_f32 v197, v197
    v_mfma_f32_16x16x32_bf16 v[84:87], v[8:11], v[100:103], v[84:87]
    v_exp_f32 v198, v198
    v_exp_f32 v199, v199
    v_mfma_f32_32x32x16_bf16 v[176:191], v[208:211], v[152:155], 0
    v_cvt_pk_bf16_f32 v104, v192, v193
    v_cvt_pk_bf16_f32 v105, v194, v195
    v_cvt_pk_bf16_f32 v106, v196, v197
    v_cvt_pk_bf16_f32 v107, v198, v199
    v_exp_f32 v200, v200
    v_mfma_f32_32x32x16_bf16 v[176:191], v[212:215], v[156:159], v[176:191]
    v_exp_f32 v201, v201
    v_exp_f32 v202, v202
    v_exp_f32 v203, v203
    v_exp_f32 v204, v204
    v_mfma_f32_32x32x16_bf16 v[32:47], v[136:139], v[104:107], v[32:47]
    v_exp_f32 v205, v205
    v_exp_f32 v206, v206
    v_exp_f32 v207, v207
    v_cvt_pk_bf16_f32 v108, v200, v201
    v_mfma_f32_16x16x32_bf16 v[84:87], v[8:11], v[104:107], v[84:87]
    v_cvt_pk_bf16_f32 v109, v202, v203
    v_cvt_pk_bf16_f32 v110, v204, v205
    v_cvt_pk_bf16_f32 v111, v206, v207
    v_exp_f32 v176, v176
    v_exp_f32 v177, v177
    v_mfma_f32_32x32x16_bf16 v[32:47], v[140:143], v[108:111], v[32:47]
    v_exp_f32 v178, v178
    v_exp_f32 v179, v179
    v_exp_f32 v180, v180
    v_exp_f32 v181, v181
    v_mfma_f32_16x16x32_bf16 v[84:87], v[8:11], v[108:111], v[84:87]
    v_exp_f32 v182, v182
    v_exp_f32 v183, v183
    v_mfma_f32_32x32x16_bf16 v[192:207], v[224:227], v[152:155], 0
    v_cvt_pk_bf16_f32 v96, v176, v177
    v_cvt_pk_bf16_f32 v97, v178, v179
    v_cvt_pk_bf16_f32 v98, v180, v181
    v_cvt_pk_bf16_f32 v99, v182, v183
    v_exp_f32 v184, v184
    v_mfma_f32_32x32x16_bf16 v[192:207], v[228:231], v[156:159], v[192:207]
    v_exp_f32 v185, v185
    v_exp_f32 v186, v186
    v_exp_f32 v187, v187
    v_exp_f32 v188, v188
    v_mfma_f32_32x32x16_bf16 v[32:47], v[216:219], v[96:99], v[32:47]
    v_exp_f32 v189, v189
    v_exp_f32 v190, v190
    v_exp_f32 v191, v191
    v_cvt_pk_bf16_f32 v100, v184, v185
    v_mfma_f32_16x16x32_bf16 v[84:87], v[12:15], v[96:99], v[84:87]
    v_cvt_pk_bf16_f32 v101, v186, v187
    v_cvt_pk_bf16_f32 v102, v188, v189
    v_cvt_pk_bf16_f32 v103, v190, v191
    s_getreg_b32 s58, hwreg(HW_REG_IB_STS, 0, 4)
    s_or_b32 s58, s58, s75
    s_cmp_eq_u32 s58, 0
    s_cbranch_scc1 Ltg_60
Ltb_61:
    v_exp_f32 v192, v192
    v_exp_f32 v193, v193
    v_mfma_f32_32x32x16_bf16 v[32:47], v[220:223], v[100:103], v[32:47]
    v_exp_f32 v194, v194
    v_exp_f32 v195, v195
    v_exp_f32 v196, v196
    v_exp_f32 v197, v197
    v_mfma_f32_16x16x32_bf16 v[84:87], v[12:15], v[100:103], v[84:87]
    v_exp_f32 v198, v198
    v_exp_f32 v199, v199
    v_mfma_f32_32x32x16_bf16 v[176:191], v[112:115], v[144:147], 0
    v_cvt_pk_bf16_f32 v104, v192, v193
    v_cvt_pk_bf16_f32 v105, v194, v195
    v_cvt_pk_bf16_f32 v106, v196, v197
    v_cvt_pk_bf16_f32 v107, v198, v199
    v_exp_f32 v200, v200
    v_mfma_f32_32x32x16_bf16 v[176:191], v[116:119], v[148:151], v[176:191]
    v_exp_f32 v201, v201
    v_exp_f32 v202, v202
    v_exp_f32 v203, v203
    v_exp_f32 v204, v204
    v_mfma_f32_32x32x16_bf16 v[32:47], v[232:235], v[104:107], v[32:47]
    v_exp_f32 v205, v205
    v_exp_f32 v206, v206
    v_exp_f32 v207, v207
    v_cvt_pk_bf16_f32 v108, v200, v201
    v_mfma_f32_16x16x32_bf16 v[84:87], v[12:15], v[104:107], v[84:87]
    v_cvt_pk_bf16_f32 v109, v202, v203
    v_cvt_pk_bf16_f32 v110, v204, v205
    v_cvt_pk_bf16_f32 v111, v206, v207
    s_getreg_b32 s58, hwreg(HW_REG_IB_STS, 0, 4)
    s_or_b32 s58, s58, s75
    s_cmp_eq_u32 s58, 0
    s_cbranch_scc1 Ltg_62
Ltb_63:
    ds_read_b32 v1, v0 offset:17456
    v_exp_f32 v176, v176
    v_exp_f32 v177, v177
    v_mfma_f32_32x32x16_bf16 v[32:47], v[236:239], v[108:111], v[32:47]
    v_exp_f32 v178, v178
    v_exp_f32 v179, v179
    v_exp_f32 v180, v180
    v_exp_f32 v181, v181
    v_mfma_f32_16x16x32_bf16 v[84:87], v[12:15], v[108:111], v[84:87]
    v_exp_f32 v182, v182
    v_exp_f32 v183, v183
    v_mfma_f32_32x32x16_bf16 v[192:207], v[128:131], v[144:147], 0
    v_cvt_pk_bf16_f32 v96, v176, v177
    v_cvt_pk_bf16_f32 v97, v178, v179
    v_cvt_pk_bf16_f32 v98, v180, v181
    v_cvt_pk_bf16_f32 v99, v182, v183
    v_exp_f32 v184, v184
    v_mfma_f32_32x32x16_bf16 v[192:207], v[132:135], v[148:151], v[192:207]
    v_exp_f32 v185, v185
    v_exp_f32 v186, v186
    v_exp_f32 v187, v187
    v_exp_f32 v188, v188
    v_mfma_f32_32x32x16_bf16 v[16:31], v[120:123], v[96:99], 0
    v_exp_f32 v189, v189
    v_exp_f32 v190, v190
    v_exp_f32 v191, v191
    v_cvt_pk_bf16_f32 v100, v184, v185
    v_mfma_f32_16x16x32_bf16 v[80:83], v[8:11], v[96:99], 0
    v_cvt_pk_bf16_f32 v101, v186, v187
    v_cvt_pk_bf16_f32 v102, v188, v189
    v_cvt_pk_bf16_f32 v103, v190, v191
    s_add_u32 s59, s60, 1
    s_waitcnt lgkmcnt(0)
    v_cmp_ne_u32 vcc, s59, v1
    s_cbranch_vccnz Lcg_64
Lcb_65:
    v_cndmask_b32 v7, v84, v85, s[72:73]
    ds_write_b128 v4, v[32:35] offset:4096
    ds_write_b128 v4, v[36:39] offset:5120
    ds_write_b128 v4, v[40:43] offset:6144
    ds_write_b128 v4, v[44:47] offset:7168
    ds_write_b32 v5, v7 offset:16640
    s_add_u32 s58, s60, 2
    v_mov_b32 v1, s58
    ds_write_b32 v0, v1 offset:17448
    s_getreg_b32 s58, hwreg(HW_REG_IB_STS, 0, 4)
    s_or_b32 s58, s58, s75
    s_cmp_eq_u32 s58, 0
    s_cbranch_scc1 Ltg_66
Ltb_67:
    v_exp_f32 v192, v192
    v_exp_f32 v193, v193
    v_mfma_f32_32x32x16_bf16 v[16:31], v[124:127], v[100:103], v[16:31]
    v_exp_f32 v194, v194
    v_exp_f32 v195, v195
    v_exp_f32 v196, v196
    v_exp_f32 v197, v197
    v_mfma_f32_16x16x32_bf16 v[80:83], v[8:11], v[100:103], v[80:83]
    v_exp_f32 v198, v198
    v_exp_f32 v199, v199
    v_mfma_f32_32x32x16_bf16 v[176:191], v[208:211], v[144:147], 0
    v_cvt_pk_bf16_f32 v104, v192, v193
    v_cvt_pk_bf16_f32 v105, v194, v195
    v_cvt_pk_bf16_f32 v106, v196, v197
    v_cvt_pk_bf16_f32 v107, v198, v199
    v_exp_f32 v200, v200
    v_mfma_f32_32x32x16_bf16 v[176:191], v[212:215], v[148:151], v[176:191]
    v_exp_f32 v201, v201
    v_exp_f32 v202, v202
    v_exp_f32 v203, v203
    v_exp_f32 v204, v204
    v_mfma_f32_32x32x16_bf16 v[16:31], v[136:139], v[104:107], v[16:31]
    v_exp_f32 v205, v205
    v_exp_f32 v206, v206
    v_exp_f32 v207, v207
    v_cvt_pk_bf16_f32 v108, v200, v201
    v_mfma_f32_16x16x32_bf16 v[80:83], v[8:11], v[104:107], v[80:83]
    v_cvt_pk_bf16_f32 v109, v202, v203
    v_cvt_pk_bf16_f32 v110, v204, v205
    v_cvt_pk_bf16_f32 v111, v206, v207
    s_getreg_b32 s58, hwreg(HW_REG_IB_STS, 0, 4)
    s_or_b32 s58, s58, s75
    s_cmp_eq_u32 s58, 0
    s_cbranch_scc1 Ltg_68
Ltb_69:
    v_exp_f32 v176, v176
    v_exp_f32 v177, v177
    v_mfma_f32_32x32x16_bf16 v[16:31], v[140:143], v[108:111], v[16:31]
    v_exp_f32 v178, v178
    v_exp_f32 v179, v179
    v_exp_f32 v180, v180
    v_exp_f32 v181, v181
    v_mfma_f32_16x16x32_bf16 v[80:83], v[8:11], v[108:111], v[80:83]
    v_exp_f32 v182, v182
    v_exp_f32 v183, v183
    v_mfma_f32_32x32x16_bf16 v[192:207], v[224:227], v[144:147], 0
    v_cvt_pk_bf16_f32 v96, v176, v177
    v_cvt_pk_bf16_f32 v97, v178, v179
    v_cvt_pk_bf16_f32 v98, v180, v181
    v_cvt_pk_bf16_f32 v99, v182, v183
    v_exp_f32 v184, v184
    v_mfma_f32_32x32x16_bf16 v[192:207], v[228:231], v[148:151], v[192:207]
    v_exp_f32 v185, v185
    v_exp_f32 v186, v186
    v_exp_f32 v187, v187
    v_exp_f32 v188, v188
    v_mfma_f32_32x32x16_bf16 v[16:31], v[216:219], v[96:99], v[16:31]
    v_exp_f32 v189, v189
    v_exp_f32 v190, v190
    v_exp_f32 v191, v191
    v_cvt_pk_bf16_f32 v100, v184, v185
    v_mfma_f32_16x16x32_bf16 v[80:83], v[12:15], v[96:99], v[80:83]
    v_cvt_pk_bf16_f32 v101, v186, v187
    v_cvt_pk_bf16_f32 v102, v188, v189
    v_cvt_pk_bf16_f32 v103, v190, v191
    s_getreg_b32 s58, hwreg(HW_REG_IB_STS, 0, 4)
    s_or_b32 s58, s58, s75
    s_cmp_eq_u32 s58, 0
    s_cbranch_scc1 Ltg_70
Ltb_71:
    ds_read_b32 v1, v0 offset:17440
    v_exp_f32 v192, v192
    v_exp_f32 v193, v193
    v_mfma_f32_32x32x16_bf16 v[16:31], v[220:223], v[100:103], v[16:31]
    v_exp_f32 v194, v194
    v_exp_f32 v195, v195
    v_exp_f32 v196, v196
    v_exp_f32 v197, v197
    v_mfma_f32_16x16x32_bf16 v[80:83], v[12:15], v[100:103], v[80:83]
    v_exp_f32 v198, v198
    v_exp_f32 v199, v199
    v_cvt_pk_bf16_f32 v104, v192, v193
    v_cvt_pk_bf16_f32 v105, v194, v195
    v_cvt_pk_bf16_f32 v106, v196, v197
    v_cvt_pk_bf16_f32 v107, v198, v199
    v_exp_f32 v200, v200
    v_exp_f32 v201, v201
    v_exp_f32 v202, v202
    v_exp_f32 v203, v203
    v_exp_f32 v204, v204
    v_mfma_f32_32x32x16_bf16 v[16:31], v[232:235], v[104:107], v[16:31]
    v_exp_f32 v205, v205
    v_exp_f32 v206, v206
    v_exp_f32 v207, v207
    v_cvt_pk_bf16_f32 v108, v200, v201
    v_mfma_f32_16x16x32_bf16 v[80:83], v[12:15], v[104:107], v[80:83]
    v_cvt_pk_bf16_f32 v109, v202, v203
    v_cvt_pk_bf16_f32 v110, v204, v205
    v_cvt_pk_bf16_f32 v111, v206, v207
    s_nop 1
    v_mfma_f32_32x32x16_bf16 v[16:31], v[236:239], v[108:111], v[16:31]
    v_mfma_f32_16x16x32_bf16 v[80:83], v[12:15], v[108:111], v[80:83]
    s_add_u32 s59, s60, 2
    s_waitcnt lgkmcnt(0)
    v_cmp_ne_u32 vcc, s59, v1
    s_cbranch_vccnz Lcg_72
Lcb_73:
    ds_read_b128 v[32:35], v4 offset:0
    ds_read_b128 v[36:39], v4 offset:1024
    ds_read_b128 v[40:43], v4 offset:2048
    ds_read_b128 v[44:47], v4 offset:3072
    ds_read_b32 v84, v5 offset:16384
    s_cmp_eq_u32 s75, 0
    s_cbranch_scc1 Ltg_74
Ltb_75:
    s_nop 4
    v_cndmask_b32 v85, v80, v81, s[72:73]
    s_add_u32 s58, s60, 2
    v_mov_b32 v1, s58
    s_waitcnt lgkmcnt(0)
    ds_write_b32 v0, v1 offset:17464
    v_add_f32 v85, v85, v84
    v_rcp_f32 v86, v85
    v_pk_add_f32 v[16:17], v[16:17], v[32:33]
    v_pk_add_f32 v[18:19], v[18:19], v[34:35]
    v_pk_add_f32 v[20:21], v[20:21], v[36:37]
    v_pk_add_f32 v[22:23], v[22:23], v[38:39]
    v_pk_add_f32 v[24:25], v[24:25], v[40:41]
    v_pk_add_f32 v[26:27], v[26:27], v[42:43]
    v_pk_add_f32 v[28:29], v[28:29], v[44:45]
    v_pk_add_f32 v[30:31], v[30:31], v[46:47]
    v_pk_mul_f32 v[32:33], v[16:17], v[86:87] op_sel_hi:[1,0]
    v_pk_mul_f32 v[34:35], v[18:19], v[86:87] op_sel_hi:[1,0]
    v_pk_mul_f32 v[36:37], v[20:21], v[86:87] op_sel_hi:[1,0]
    v_pk_mul_f32 v[38:39], v[22:23], v[86:87] op_sel_hi:[1,0]
    v_pk_mul_f32 v[40:41], v[24:25], v[86:87] op_sel_hi:[1,0]
    v_pk_mul_f32 v[42:43], v[26:27], v[86:87] op_sel_hi:[1,0]
    v_pk_mul_f32 v[44:45], v[28:29], v[86:87] op_sel_hi:[1,0]
    v_pk_mul_f32 v[46:47], v[30:31], v[86:87] op_sel_hi:[1,0]
    v_cvt_pk_bf16_f32 v32, v32, v33
    v_cvt_pk_bf16_f32 v33, v34, v35
    v_cvt_pk_bf16_f32 v34, v36, v37
    v_cvt_pk_bf16_f32 v35, v38, v39
    v_cvt_pk_bf16_f32 v36, v40, v41
    v_cvt_pk_bf16_f32 v37, v42, v43
    v_cvt_pk_bf16_f32 v38, v44, v45
    v_cvt_pk_bf16_f32 v39, v46, v47
    s_add_u32 s58, s66, 0
    buffer_store_dwordx4 v[32:35], v6, s[32:35], s58 offen sc1
    buffer_store_dwordx4 v[36:39], v6, s[32:35], s58 offen offset:512 sc1
    v_pk_mul_f32 v[40:41], v[16:17], 0
    v_pk_mul_f32 v[42:43], v[18:19], 0
    v_pk_fma_f32 v[40:41], v[20:21], 0, v[40:41]
    v_pk_fma_f32 v[42:43], v[22:23], 0, v[42:43]
    v_pk_fma_f32 v[40:41], v[24:25], 0, v[40:41]
    v_pk_fma_f32 v[42:43], v[26:27], 0, v[42:43]
    v_pk_fma_f32 v[40:41], v[28:29], 0, v[40:41]
    v_pk_fma_f32 v[42:43], v[30:31], 0, v[42:43]
    v_pk_add_f32 v[40:41], v[40:41], v[42:43]
    v_add_f32 v40, v40, v41
    v_add_f32 v40, v40, v85
    v_cmp_le_f32 vcc, 0x30800000, v40
    s_mov_b64 s[56:57], vcc
    v_cmp_ge_f32 vcc, 0x4e800000, v40
    s_and_b64 s[56:57], s[56:57], vcc
    s_cmp_eq_u64 s[56:57], -1
    s_cselect_b32 s75, 0, 2
    s_or_b32 s63, s63, s75
    s_cmp_eq_u32 s75, 0
    s_cbranch_scc1 Ltg_76
Ltb_77:
    s_cmp_lg_u32 s63, 0
    s_cbranch_scc1 Lslow_78
Lslowb_79:
L_p3:
    s_cmp_lg_u32 s42, 0
    s_cbranch_scc1 L_np2
    v_lshlrev_b32 v4, 5, v2
    s_lshl_b32 s50, s41, 12
    s_add_u32 s50, s50, 13631488
    s_mov_b32 s54, 0
L_po2:
    buffer_load_dwordx2 v[6:7], v4, s[32:35], s50 offen sc1
    s_add_u32 s54, s54, 1
    s_cmp_gt_u32 s54, 400000
    s_cbranch_scc1 L_po2g
    s_waitcnt vmcnt(0)
    v_cmp_ne_u64 vcc, s[60:61], v[6:7]
    s_cbranch_vccz L_po2g
    s_sleep 2
    s_branch L_po2
L_po2g:
    v_mov_b32 v14, 0
    s_add_u32 s58, s60, 1
    v_mov_b32 v15, s58
    ds_write_b32 v14, v15 offset:17556
L_np2:
    s_lshl_b32 s48, s41, 2
    s_add_u32 s48, s48, s44
    s_lshl_b32 s49, s48, 5
    s_lshl_b32 s50, s45, 4
    s_add_u32 s49, s49, s50
    s_lshl_b32 s49, s49, 11
    s_add_u32 s49, s49, 8388608
    v_lshrrev_b32 v5, 4, v2
    v_bfe_u32 v6, v2, 2, 2
    v_lshrrev_b32 v7, 1, v5
    v_lshlrev_b32 v7, 4, v7
    v_and_b32 v8, 1, v5
    v_lshl_add_u32 v7, v8, 2, v7
    v_add_u32 v7, v7, v6
    v_bfe_u32 v8, v7, 1, 2
    v_lshlrev_b32 v7, 7, v7
    v_lshl_add_u32 v7, v8, 5, v7
    v_and_b32 v6, 3, v2
    v_lshl_add_u32 v7, v6, 3, v7
    s_lshl_b32 s51, s45, 16
    s_add_u32 s51, s51, 32768
    v_add_u32 v10, s51, v7
    v_xor_b32 v11, 32, v10
    v_xor_b32 v12, 64, v10
    v_xor_b32 v13, 96, v10
    s_lshl_b32 s52, s48, 5
    s_lshl_b32 s53, s45, 4
    s_add_u32 s52, s52, s53
    v_and_b32 v5, 15, v2
    v_add_u32 v5, s52, v5
    v_lshlrev_b32 v5, 11, v5
    v_bfe_u32 v6, v2, 4, 1
    v_lshl_add_u32 v5, v6, 5, v5
    v_lshrrev_b32 v6, 5, v2
    v_lshl_add_u32 v5, v6, 4, v5
    s_lshl_b32 s50, s40, 7
    v_add_u32 v5, s50, v5
    s_lshl_b32 s58, s44, 13
    v_add_u32 v4, s58, v3
    v_and_b32 v14, 3, v2
    v_lshlrev_b32 v14, 2, v14
    s_add_u32 s59, s60, 1
Lw_80:
    ds_read_b32 v15, v14 offset:17488
    s_waitcnt lgkmcnt(0)
    v_cmp_ne_u32 vcc, s59, v15
    s_cbranch_vccz Lwd_81
    s_sleep 1
    s_branch Lw_80
Lwd_81:
    ds_read_b64_tr_b16 v[48:49], v10 offset:0
    ds_read_b64_tr_b16 v[50:51], v10 offset:1024
    ds_read_b64_tr_b16 v[52:53], v11 offset:0
    ds_read_b64_tr_b16 v[54:55], v11 offset:1024
    ds_read_b64_tr_b16 v[56:57], v12 offset:0
    ds_read_b64_tr_b16 v[58:59], v12 offset:1024
    ds_read_b64_tr_b16 v[60:61], v13 offset:0
    ds_read_b64_tr_b16 v[62:63], v13 offset:1024
    v_mov_b32 v14, 0
    s_add_u32 s59, s60, 1
Lw_82:
    ds_read_b32 v15, v14 offset:17556
    s_waitcnt lgkmcnt(0)
    v_cmp_ne_u32 vcc, s59, v15
    s_cbranch_vccz Lwd_83
    s_sleep 1
    s_branch Lw_82
Lwd_83:
    buffer_load_dwordx4 v[96:99], v3, s[32:35], s49 offen offset:0 sc1
    buffer_load_dwordx4 v[100:103], v3, s[32:35], s49 offen offset:1024 sc1
    buffer_load_dwordx4 v[104:107], v3, s[32:35], s49 offen offset:2048 sc1
    buffer_load_dwordx4 v[108:111], v3, s[32:35], s49 offen offset:3072 sc1
    s_add_u32 s49, s49, 4096
    buffer_load_dwordx4 v[112:115], v3, s[32:35], s49 offen offset:0 sc1
    buffer_load_dwordx4 v[116:119], v3, s[32:35], s49 offen offset:1024 sc1
    buffer_load_dwordx4 v[120:123], v3, s[32:35], s49 offen offset:2048 sc1
    buffer_load_dwordx4 v[124:127], v3, s[32:35], s49 offen offset:3072 sc1
    s_add_u32 s49, s49, 4096
    s_waitcnt vmcnt(7) lgkmcnt(6)
    v_mfma_f32_16x16x32_bf16 v[16:19], v[48:51], v[96:99], 0
    ds_read_b64_tr_b16 v[64:65], v10 offset:4096
    s_waitcnt vmcnt(6)
    v_mfma_f32_16x16x32_bf16 v[32:35], v[48:51], v[100:103], 0
    ds_read_b64_tr_b16 v[66:67], v10 offset:5120
    s_waitcnt lgkmcnt(6)
    v_mfma_f32_16x16x32_bf16 v[20:23], v[52:55], v[96:99], 0
    ds_read_b64_tr_b16 v[68:69], v11 offset:4096
    buffer_load_dwordx4 v[128:131], v3, s[32:35], s49 offen offset:0 sc1
    v_mfma_f32_16x16x32_bf16 v[36:39], v[52:55], v[100:103], 0
    ds_read_b64_tr_b16 v[70:71], v11 offset:5120
    s_waitcnt lgkmcnt(6)
    v_mfma_f32_16x16x32_bf16 v[24:27], v[56:59], v[96:99], 0
    ds_read_b64_tr_b16 v[72:73], v12 offset:4096
    v_mfma_f32_16x16x32_bf16 v[40:43], v[56:59], v[100:103], 0
    ds_read_b64_tr_b16 v[74:75], v12 offset:5120
    buffer_load_dwordx4 v[132:135], v3, s[32:35], s49 offen offset:1024 sc1
    s_waitcnt lgkmcnt(6)
    v_mfma_f32_16x16x32_bf16 v[28:31], v[60:63], v[96:99], 0
    ds_read_b64_tr_b16 v[76:77], v13 offset:4096
    v_mfma_f32_16x16x32_bf16 v[44:47], v[60:63], v[100:103], 0
    ds_read_b64_tr_b16 v[78:79], v13 offset:5120
    s_waitcnt vmcnt(7) lgkmcnt(6)
    v_mfma_f32_16x16x32_bf16 v[16:19], v[64:67], v[104:107], v[16:19]
    ds_read_b64_tr_b16 v[48:49], v10 offset:8192
    s_waitcnt vmcnt(6)
    v_mfma_f32_16x16x32_bf16 v[32:35], v[64:67], v[108:111], v[32:35]
    ds_read_b64_tr_b16 v[50:51], v10 offset:9216
    s_waitcnt lgkmcnt(6)
    v_mfma_f32_16x16x32_bf16 v[20:23], v[68:71], v[104:107], v[20:23]
    ds_read_b64_tr_b16 v[52:53], v11 offset:8192
    buffer_load_dwordx4 v[136:139], v3, s[32:35], s49 offen offset:2048 sc1
    v_mfma_f32_16x16x32_bf16 v[36:39], v[68:71], v[108:111], v[36:39]
    ds_read_b64_tr_b16 v[54:55], v11 offset:9216
    s_waitcnt lgkmcnt(6)
    v_mfma_f32_16x16x32_bf16 v[24:27], v[72:75], v[104:107], v[24:27]
    ds_read_b64_tr_b16 v[56:57], v12 offset:8192
    v_mfma_f32_16x16x32_bf16 v[40:43], v[72:75], v[108:111], v[40:43]
    ds_read_b64_tr_b16 v[58:59], v12 offset:9216
    buffer_load_dwordx4 v[140:143], v3, s[32:35], s49 offen offset:3072 sc1
    s_add_u32 s49, s49, 4096
    s_waitcnt lgkmcnt(6)
    v_mfma_f32_16x16x32_bf16 v[28:31], v[76:79], v[104:107], v[28:31]
    ds_read_b64_tr_b16 v[60:61], v13 offset:8192
    v_mfma_f32_16x16x32_bf16 v[44:47], v[76:79], v[108:111], v[44:47]
    ds_read_b64_tr_b16 v[62:63], v13 offset:9216
    s_waitcnt vmcnt(7) lgkmcnt(6)
    v_mfma_f32_16x16x32_bf16 v[16:19], v[48:51], v[112:115], v[16:19]
    ds_read_b64_tr_b16 v[64:65], v10 offset:12288
    s_waitcnt vmcnt(6)
    v_mfma_f32_16x16x32_bf16 v[32:35], v[48:51], v[116:119], v[32:35]
    ds_read_b64_tr_b16 v[66:67], v10 offset:13312
    s_waitcnt lgkmcnt(6)
    v_mfma_f32_16x16x32_bf16 v[20:23], v[52:55], v[112:115], v[20:23]
    ds_read_b64_tr_b16 v[68:69], v11 offset:12288
    buffer_load_dwordx4 v[144:147], v3, s[32:35], s49 offen offset:0 sc1
    v_mfma_f32_16x16x32_bf16 v[36:39], v[52:55], v[116:119], v[36:39]
    ds_read_b64_tr_b16 v[70:71], v11 offset:13312
    s_waitcnt lgkmcnt(6)
    v_mfma_f32_16x16x32_bf16 v[24:27], v[56:59], v[112:115], v[24:27]
    ds_read_b64_tr_b16 v[72:73], v12 offset:12288
    v_mfma_f32_16x16x32_bf16 v[40:43], v[56:59], v[116:119], v[40:43]
    ds_read_b64_tr_b16 v[74:75], v12 offset:13312
    buffer_load_dwordx4 v[148:151], v3, s[32:35], s49 offen offset:1024 sc1
    s_waitcnt lgkmcnt(6)
    v_mfma_f32_16x16x32_bf16 v[28:31], v[60:63], v[112:115], v[28:31]
    ds_read_b64_tr_b16 v[76:77], v13 offset:12288
    v_mfma_f32_16x16x32_bf16 v[44:47], v[60:63], v[116:119], v[44:47]
    ds_read_b64_tr_b16 v[78:79], v13 offset:13312
    s_waitcnt vmcnt(7) lgkmcnt(6)
    v_mfma_f32_16x16x32_bf16 v[16:19], v[64:67], v[120:123], v[16:19]
    ds_read_b64_tr_b16 v[48:49], v10 offset:16384
    s_waitcnt vmcnt(6)
    v_mfma_f32_16x16x32_bf16 v[32:35], v[64:67], v[124:127], v[32:35]
    ds_read_b64_tr_b16 v[50:51], v10 offset:17408
    s_waitcnt lgkmcnt(6)
    v_mfma_f32_16x16x32_bf16 v[20:23], v[68:71], v[120:123], v[20:23]
    ds_read_b64_tr_b16 v[52:53], v11 offset:16384
    buffer_load_dwordx4 v[152:155], v3, s[32:35], s49 offen offset:2048 sc1
    v_mfma_f32_16x16x32_bf16 v[36:39], v[68:71], v[124:127], v[36:39]
    ds_read_b64_tr_b16 v[54:55], v11 offset:17408
    s_waitcnt lgkmcnt(6)
    v_mfma_f32_16x16x32_bf16 v[24:27], v[72:75], v[120:123], v[24:27]
    ds_read_b64_tr_b16 v[56:57], v12 offset:16384
    v_mfma_f32_16x16x32_bf16 v[40:43], v[72:75], v[124:127], v[40:43]
    ds_read_b64_tr_b16 v[58:59], v12 offset:17408
    buffer_load_dwordx4 v[156:159], v3, s[32:35], s49 offen offset:3072 sc1
    s_add_u32 s49, s49, 4096
    s_waitcnt lgkmcnt(6)
    v_mfma_f32_16x16x32_bf16 v[28:31], v[76:79], v[120:123], v[28:31]
    ds_read_b64_tr_b16 v[60:61], v13 offset:16384
    v_mfma_f32_16x16x32_bf16 v[44:47], v[76:79], v[124:127], v[44:47]
    ds_read_b64_tr_b16 v[62:63], v13 offset:17408
    s_waitcnt vmcnt(7) lgkmcnt(6)
    v_mfma_f32_16x16x32_bf16 v[16:19], v[48:51], v[128:131], v[16:19]
    ds_read_b64_tr_b16 v[64:65], v10 offset:20480
    s_waitcnt vmcnt(6)
    v_mfma_f32_16x16x32_bf16 v[32:35], v[48:51], v[132:135], v[32:35]
    ds_read_b64_tr_b16 v[66:67], v10 offset:21504
    s_waitcnt lgkmcnt(6)
    v_mfma_f32_16x16x32_bf16 v[20:23], v[52:55], v[128:131], v[20:23]
    ds_read_b64_tr_b16 v[68:69], v11 offset:20480
    buffer_load_dwordx4 v[160:163], v3, s[32:35], s49 offen offset:0 sc1
    v_mfma_f32_16x16x32_bf16 v[36:39], v[52:55], v[132:135], v[36:39]
    ds_read_b64_tr_b16 v[70:71], v11 offset:21504
    s_waitcnt lgkmcnt(6)
    v_mfma_f32_16x16x32_bf16 v[24:27], v[56:59], v[128:131], v[24:27]
    ds_read_b64_tr_b16 v[72:73], v12 offset:20480
    v_mfma_f32_16x16x32_bf16 v[40:43], v[56:59], v[132:135], v[40:43]
    ds_read_b64_tr_b16 v[74:75], v12 offset:21504
    buffer_load_dwordx4 v[164:167], v3, s[32:35], s49 offen offset:1024 sc1
    s_waitcnt lgkmcnt(6)
    v_mfma_f32_16x16x32_bf16 v[28:31], v[60:63], v[128:131], v[28:31]
    ds_read_b64_tr_b16 v[76:77], v13 offset:20480
    v_mfma_f32_16x16x32_bf16 v[44:47], v[60:63], v[132:135], v[44:47]
    ds_read_b64_tr_b16 v[78:79], v13 offset:21504
    s_waitcnt vmcnt(7) lgkmcnt(6)
    v_mfma_f32_16x16x32_bf16 v[16:19], v[64:67], v[136:139], v[16:19]
    ds_read_b64_tr_b16 v[48:49], v10 offset:24576
    s_waitcnt vmcnt(6)
    v_mfma_f32_16x16x32_bf16 v[32:35], v[64:67], v[140:143], v[32:35]
    ds_read_b64_tr_b16 v[50:51], v10 offset:25600
    s_waitcnt lgkmcnt(6)
    v_mfma_f32_16x16x32_bf16 v[20:23], v[68:71], v[136:139], v[20:23]
    ds_read_b64_tr_b16 v[52:53], v11 offset:24576
    buffer_load_dwordx4 v[168:171], v3, s[32:35], s49 offen offset:2048 sc1
    v_mfma_f32_16x16x32_bf16 v[36:39], v[68:71], v[140:143], v[36:39]
    ds_read_b64_tr_b16 v[54:55], v11 offset:25600
    s_waitcnt lgkmcnt(6)
    v_mfma_f32_16x16x32_bf16 v[24:27], v[72:75], v[136:139], v[24:27]
    ds_read_b64_tr_b16 v[56:57], v12 offset:24576
    v_mfma_f32_16x16x32_bf16 v[40:43], v[72:75], v[140:143], v[40:43]
    ds_read_b64_tr_b16 v[58:59], v12 offset:25600
    buffer_load_dwordx4 v[172:175], v3, s[32:35], s49 offen offset:3072 sc1
    s_add_u32 s49, s49, 4096
    s_waitcnt lgkmcnt(6)
    v_mfma_f32_16x16x32_bf16 v[28:31], v[76:79], v[136:139], v[28:31]
    ds_read_b64_tr_b16 v[60:61], v13 offset:24576
    v_mfma_f32_16x16x32_bf16 v[44:47], v[76:79], v[140:143], v[44:47]
    ds_read_b64_tr_b16 v[62:63], v13 offset:25600
    s_waitcnt vmcnt(7) lgkmcnt(6)
    v_mfma_f32_16x16x32_bf16 v[16:19], v[48:51], v[144:147], v[16:19]
    ds_read_b64_tr_b16 v[64:65], v10 offset:28672
    s_waitcnt vmcnt(6)
    v_mfma_f32_16x16x32_bf16 v[32:35], v[48:51], v[148:151], v[32:35]
    ds_read_b64_tr_b16 v[66:67], v10 offset:29696
    s_waitcnt lgkmcnt(6)
    v_mfma_f32_16x16x32_bf16 v[20:23], v[52:55], v[144:147], v[20:23]
    ds_read_b64_tr_b16 v[68:69], v11 offset:28672
    buffer_load_dwordx4 v[176:179], v3, s[32:35], s49 offen offset:0 sc1
    v_mfma_f32_16x16x32_bf16 v[36:39], v[52:55], v[148:151], v[36:39]
    ds_read_b64_tr_b16 v[70:71], v11 offset:29696
    s_waitcnt lgkmcnt(6)
    v_mfma_f32_16x16x32_bf16 v[24:27], v[56:59], v[144:147], v[24:27]
    ds_read_b64_tr_b16 v[72:73], v12 offset:28672
    v_mfma_f32_16x16x32_bf16 v[40:43], v[56:59], v[148:151], v[40:43]
    ds_read_b64_tr_b16 v[74:75], v12 offset:29696
    buffer_load_dwordx4 v[180:183], v3, s[32:35], s49 offen offset:1024 sc1
    s_waitcnt lgkmcnt(6)
    v_mfma_f32_16x16x32_bf16 v[28:31], v[60:63], v[144:147], v[28:31]
    ds_read_b64_tr_b16 v[76:77], v13 offset:28672
    v_mfma_f32_16x16x32_bf16 v[44:47], v[60:63], v[148:151], v[44:47]
    ds_read_b64_tr_b16 v[78:79], v13 offset:29696
    s_waitcnt vmcnt(7) lgkmcnt(6)
    v_mfma_f32_16x16x32_bf16 v[16:19], v[64:67], v[152:155], v[16:19]
    ds_read_b64_tr_b16 v[48:49], v10 offset:32768
    s_waitcnt vmcnt(6)
    v_mfma_f32_16x16x32_bf16 v[32:35], v[64:67], v[156:159], v[32:35]
    ds_read_b64_tr_b16 v[50:51], v10 offset:33792
    s_waitcnt lgkmcnt(6)
    v_mfma_f32_16x16x32_bf16 v[20:23], v[68:71], v[152:155], v[20:23]
    ds_read_b64_tr_b16 v[52:53], v11 offset:32768
    buffer_load_dwordx4 v[184:187], v3, s[32:35], s49 offen offset:2048 sc1
    v_mfma_f32_16x16x32_bf16 v[36:39], v[68:71], v[156:159], v[36:39]
    ds_read_b64_tr_b16 v[54:55], v11 offset:33792
    s_waitcnt lgkmcnt(6)
    v_mfma_f32_16x16x32_bf16 v[24:27], v[72:75], v[152:155], v[24:27]
    ds_read_b64_tr_b16 v[56:57], v12 offset:32768
    v_mfma_f32_16x16x32_bf16 v[40:43], v[72:75], v[156:159], v[40:43]
    ds_read_b64_tr_b16 v[58:59], v12 offset:33792
    buffer_load_dwordx4 v[188:191], v3, s[32:35], s49 offen offset:3072 sc1
    s_add_u32 s49, s49, 4096
    s_waitcnt lgkmcnt(6)
    v_mfma_f32_16x16x32_bf16 v[28:31], v[76:79], v[152:155], v[28:31]
    ds_read_b64_tr_b16 v[60:61], v13 offset:32768
    v_mfma_f32_16x16x32_bf16 v[44:47], v[76:79], v[156:159], v[44:47]
    ds_read_b64_tr_b16 v[62:63], v13 offset:33792
    s_waitcnt vmcnt(7) lgkmcnt(6)
    v_mfma_f32_16x16x32_bf16 v[16:19], v[48:51], v[160:163], v[16:19]
    ds_read_b64_tr_b16 v[64:65], v10 offset:36864
    s_waitcnt vmcnt(6)
    v_mfma_f32_16x16x32_bf16 v[32:35], v[48:51], v[164:167], v[32:35]
    ds_read_b64_tr_b16 v[66:67], v10 offset:37888
    s_waitcnt lgkmcnt(6)
    v_mfma_f32_16x16x32_bf16 v[20:23], v[52:55], v[160:163], v[20:23]
    ds_read_b64_tr_b16 v[68:69], v11 offset:36864
    buffer_load_dwordx4 v[192:195], v3, s[32:35], s49 offen offset:0 sc1
    v_mfma_f32_16x16x32_bf16 v[36:39], v[52:55], v[164:167], v[36:39]
    ds_read_b64_tr_b16 v[70:71], v11 offset:37888
    s_waitcnt lgkmcnt(6)
    v_mfma_f32_16x16x32_bf16 v[24:27], v[56:59], v[160:163], v[24:27]
    ds_read_b64_tr_b16 v[72:73], v12 offset:36864
    v_mfma_f32_16x16x32_bf16 v[40:43], v[56:59], v[164:167], v[40:43]
    ds_read_b64_tr_b16 v[74:75], v12 offset:37888
    buffer_load_dwordx4 v[196:199], v3, s[32:35], s49 offen offset:1024 sc1
    s_waitcnt lgkmcnt(6)
    v_mfma_f32_16x16x32_bf16 v[28:31], v[60:63], v[160:163], v[28:31]
    ds_read_b64_tr_b16 v[76:77], v13 offset:36864
    v_mfma_f32_16x16x32_bf16 v[44:47], v[60:63], v[164:167], v[44:47]
    ds_read_b64_tr_b16 v[78:79], v13 offset:37888
    s_waitcnt vmcnt(7) lgkmcnt(6)
    v_mfma_f32_16x16x32_bf16 v[16:19], v[64:67], v[168:171], v[16:19]
    ds_read_b64_tr_b16 v[48:49], v10 offset:40960
    s_waitcnt vmcnt(6)
    v_mfma_f32_16x16x32_bf16 v[32:35], v[64:67], v[172:175], v[32:35]
    ds_read_b64_tr_b16 v[50:51], v10 offset:41984
    s_waitcnt lgkmcnt(6)
    v_mfma_f32_16x16x32_bf16 v[20:23], v[68:71], v[168:171], v[20:23]
    ds_read_b64_tr_b16 v[52:53], v11 offset:40960
    buffer_load_dwordx4 v[200:203], v3, s[32:35], s49 offen offset:2048 sc1
    v_mfma_f32_16x16x32_bf16 v[36:39], v[68:71], v[172:175], v[36:39]
    ds_read_b64_tr_b16 v[54:55], v11 offset:41984
    s_waitcnt lgkmcnt(6)
    v_mfma_f32_16x16x32_bf16 v[24:27], v[72:75], v[168:171], v[24:27]
    ds_read_b64_tr_b16 v[56:57], v12 offset:40960
    v_mfma_f32_16x16x32_bf16 v[40:43], v[72:75], v[172:175], v[40:43]
    ds_read_b64_tr_b16 v[58:59], v12 offset:41984
    buffer_load_dwordx4 v[204:207], v3, s[32:35], s49 offen offset:3072 sc1
    s_add_u32 s49, s49, 4096
    s_waitcnt lgkmcnt(6)
    v_mfma_f32_16x16x32_bf16 v[28:31], v[76:79], v[168:171], v[28:31]
    ds_read_b64_tr_b16 v[60:61], v13 offset:40960
    v_mfma_f32_16x16x32_bf16 v[44:47], v[76:79], v[172:175], v[44:47]
    ds_read_b64_tr_b16 v[62:63], v13 offset:41984
    s_waitcnt vmcnt(7) lgkmcnt(6)
    v_mfma_f32_16x16x32_bf16 v[16:19], v[48:51], v[176:179], v[16:19]
    ds_read_b64_tr_b16 v[64:65], v10 offset:45056
    s_waitcnt vmcnt(6)
    v_mfma_f32_16x16x32_bf16 v[32:35], v[48:51], v[180:183], v[32:35]
    ds_read_b64_tr_b16 v[66:67], v10 offset:46080
    s_waitcnt lgkmcnt(6)
    v_mfma_f32_16x16x32_bf16 v[20:23], v[52:55], v[176:179], v[20:23]
    ds_read_b64_tr_b16 v[68:69], v11 offset:45056
    buffer_load_dwordx4 v[208:211], v3, s[32:35], s49 offen offset:0 sc1
    v_mfma_f32_16x16x32_bf16 v[36:39], v[52:55], v[180:183], v[36:39]
    ds_read_b64_tr_b16 v[70:71], v11 offset:46080
    s_waitcnt lgkmcnt(6)
    v_mfma_f32_16x16x32_bf16 v[24:27], v[56:59], v[176:179], v[24:27]
    ds_read_b64_tr_b16 v[72:73], v12 offset:45056
    v_mfma_f32_16x16x32_bf16 v[40:43], v[56:59], v[180:183], v[40:43]
    ds_read_b64_tr_b16 v[74:75], v12 offset:46080
    buffer_load_dwordx4 v[212:215], v3, s[32:35], s49 offen offset:1024 sc1
    s_waitcnt lgkmcnt(6)
    v_mfma_f32_16x16x32_bf16 v[28:31], v[60:63], v[176:179], v[28:31]
    ds_read_b64_tr_b16 v[76:77], v13 offset:45056
    v_mfma_f32_16x16x32_bf16 v[44:47], v[60:63], v[180:183], v[44:47]
    ds_read_b64_tr_b16 v[78:79], v13 offset:46080
    s_waitcnt vmcnt(7) lgkmcnt(6)
    v_mfma_f32_16x16x32_bf16 v[16:19], v[64:67], v[184:187], v[16:19]
    ds_read_b64_tr_b16 v[48:49], v10 offset:49152
    s_waitcnt vmcnt(6)
    v_mfma_f32_16x16x32_bf16 v[32:35], v[64:67], v[188:191], v[32:35]
    ds_read_b64_tr_b16 v[50:51], v10 offset:50176
    s_waitcnt lgkmcnt(6)
    v_mfma_f32_16x16x32_bf16 v[20:23], v[68:71], v[184:187], v[20:23]
    ds_read_b64_tr_b16 v[52:53], v11 offset:49152
    buffer_load_dwordx4 v[216:219], v3, s[32:35], s49 offen offset:2048 sc1
    v_mfma_f32_16x16x32_bf16 v[36:39], v[68:71], v[188:191], v[36:39]
    ds_read_b64_tr_b16 v[54:55], v11 offset:50176
    s_waitcnt lgkmcnt(6)
    v_mfma_f32_16x16x32_bf16 v[24:27], v[72:75], v[184:187], v[24:27]
    ds_read_b64_tr_b16 v[56:57], v12 offset:49152
    v_mfma_f32_16x16x32_bf16 v[40:43], v[72:75], v[188:191], v[40:43]
    ds_read_b64_tr_b16 v[58:59], v12 offset:50176
    buffer_load_dwordx4 v[220:223], v3, s[32:35], s49 offen offset:3072 sc1
    s_add_u32 s49, s49, 4096
    s_waitcnt lgkmcnt(6)
    v_mfma_f32_16x16x32_bf16 v[28:31], v[76:79], v[184:187], v[28:31]
    ds_read_b64_tr_b16 v[60:61], v13 offset:49152
    v_mfma_f32_16x16x32_bf16 v[44:47], v[76:79], v[188:191], v[44:47]
    ds_read_b64_tr_b16 v[62:63], v13 offset:50176
    s_waitcnt vmcnt(7) lgkmcnt(6)
    v_mfma_f32_16x16x32_bf16 v[16:19], v[48:51], v[192:195], v[16:19]
    ds_read_b64_tr_b16 v[64:65], v10 offset:53248
    s_waitcnt vmcnt(6)
    v_mfma_f32_16x16x32_bf16 v[32:35], v[48:51], v[196:199], v[32:35]
    ds_read_b64_tr_b16 v[66:67], v10 offset:54272
    s_waitcnt lgkmcnt(6)
    v_mfma_f32_16x16x32_bf16 v[20:23], v[52:55], v[192:195], v[20:23]
    ds_read_b64_tr_b16 v[68:69], v11 offset:53248
    v_mfma_f32_16x16x32_bf16 v[36:39], v[52:55], v[196:199], v[36:39]
    ds_read_b64_tr_b16 v[70:71], v11 offset:54272
    s_waitcnt lgkmcnt(6)
    v_mfma_f32_16x16x32_bf16 v[24:27], v[56:59], v[192:195], v[24:27]
    ds_read_b64_tr_b16 v[72:73], v12 offset:53248
    v_mfma_f32_16x16x32_bf16 v[40:43], v[56:59], v[196:199], v[40:43]
    ds_read_b64_tr_b16 v[74:75], v12 offset:54272
    s_waitcnt lgkmcnt(6)
    v_mfma_f32_16x16x32_bf16 v[28:31], v[60:63], v[192:195], v[28:31]
    ds_read_b64_tr_b16 v[76:77], v13 offset:53248
    v_mfma_f32_16x16x32_bf16 v[44:47], v[60:63], v[196:199], v[44:47]
    ds_read_b64_tr_b16 v[78:79], v13 offset:54272
    s_waitcnt vmcnt(5) lgkmcnt(6)
    v_mfma_f32_16x16x32_bf16 v[16:19], v[64:67], v[200:203], v[16:19]
    ds_read_b64_tr_b16 v[48:49], v10 offset:57344
    s_waitcnt vmcnt(4)
    v_mfma_f32_16x16x32_bf16 v[32:35], v[64:67], v[204:207], v[32:35]
    ds_read_b64_tr_b16 v[50:51], v10 offset:58368
    s_waitcnt lgkmcnt(6)
    v_mfma_f32_16x16x32_bf16 v[20:23], v[68:71], v[200:203], v[20:23]
    ds_read_b64_tr_b16 v[52:53], v11 offset:57344
    v_mfma_f32_16x16x32_bf16 v[36:39], v[68:71], v[204:207], v[36:39]
    ds_read_b64_tr_b16 v[54:55], v11 offset:58368
    s_waitcnt lgkmcnt(6)
    v_mfma_f32_16x16x32_bf16 v[24:27], v[72:75], v[200:203], v[24:27]
    ds_read_b64_tr_b16 v[56:57], v12 offset:57344
    v_mfma_f32_16x16x32_bf16 v[40:43], v[72:75], v[204:207], v[40:43]
    ds_read_b64_tr_b16 v[58:59], v12 offset:58368
    s_waitcnt lgkmcnt(6)
    v_mfma_f32_16x16x32_bf16 v[28:31], v[76:79], v[200:203], v[28:31]
    ds_read_b64_tr_b16 v[60:61], v13 offset:57344
    v_mfma_f32_16x16x32_bf16 v[44:47], v[76:79], v[204:207], v[44:47]
    ds_read_b64_tr_b16 v[62:63], v13 offset:58368
    s_waitcnt vmcnt(3) lgkmcnt(6)
    v_mfma_f32_16x16x32_bf16 v[16:19], v[48:51], v[208:211], v[16:19]
    ds_read_b64_tr_b16 v[64:65], v10 offset:61440
    s_waitcnt vmcnt(2)
    v_mfma_f32_16x16x32_bf16 v[32:35], v[48:51], v[212:215], v[32:35]
    ds_read_b64_tr_b16 v[66:67], v10 offset:62464
    s_waitcnt lgkmcnt(6)
    v_mfma_f32_16x16x32_bf16 v[20:23], v[52:55], v[208:211], v[20:23]
    ds_read_b64_tr_b16 v[68:69], v11 offset:61440
    v_mfma_f32_16x16x32_bf16 v[36:39], v[52:55], v[212:215], v[36:39]
    ds_read_b64_tr_b16 v[70:71], v11 offset:62464
    s_waitcnt lgkmcnt(6)
    v_mfma_f32_16x16x32_bf16 v[24:27], v[56:59], v[208:211], v[24:27]
    ds_read_b64_tr_b16 v[72:73], v12 offset:61440
    v_mfma_f32_16x16x32_bf16 v[40:43], v[56:59], v[212:215], v[40:43]
    ds_read_b64_tr_b16 v[74:75], v12 offset:62464
    s_waitcnt lgkmcnt(6)
    v_mfma_f32_16x16x32_bf16 v[28:31], v[60:63], v[208:211], v[28:31]
    ds_read_b64_tr_b16 v[76:77], v13 offset:61440
    v_mfma_f32_16x16x32_bf16 v[44:47], v[60:63], v[212:215], v[44:47]
    ds_read_b64_tr_b16 v[78:79], v13 offset:62464
    s_waitcnt vmcnt(1) lgkmcnt(6)
    v_mfma_f32_16x16x32_bf16 v[16:19], v[64:67], v[216:219], v[16:19]
    s_waitcnt vmcnt(0)
    v_mfma_f32_16x16x32_bf16 v[32:35], v[64:67], v[220:223], v[32:35]
    s_waitcnt lgkmcnt(4)
    v_mfma_f32_16x16x32_bf16 v[20:23], v[68:71], v[216:219], v[20:23]
    v_mfma_f32_16x16x32_bf16 v[36:39], v[68:71], v[220:223], v[36:39]
    s_waitcnt lgkmcnt(2)
    v_mfma_f32_16x16x32_bf16 v[24:27], v[72:75], v[216:219], v[24:27]
    v_mfma_f32_16x16x32_bf16 v[40:43], v[72:75], v[220:223], v[40:43]
    s_waitcnt lgkmcnt(0)
    v_mfma_f32_16x16x32_bf16 v[28:31], v[76:79], v[216:219], v[28:31]
    v_mfma_f32_16x16x32_bf16 v[44:47], v[76:79], v[220:223], v[44:47]
    v_and_b32 v14, 1, v2
    v_lshl_add_u32 v14, v14, 3, v0
    s_add_u32 s59, s60, 1
Lw_84:
    ds_read_b32 v15, v14 offset:17584
    s_waitcnt lgkmcnt(0)
    v_cmp_ne_u32 vcc, s59, v15
    s_cbranch_vccnz Lw_84
    s_cmp_eq_u32 s45, 1
    s_cbranch_scc1 L_c3_p1
    ds_write_b128 v4, v[32:35] offset:0
    ds_write_b128 v4, v[36:39] offset:1024
    ds_write_b128 v4, v[40:43] offset:2048
    ds_write_b128 v4, v[44:47] offset:3072
    s_add_u32 s58, s60, 1
    v_mov_b32 v14, s58
    ds_write_b32 v0, v14 offset:17504
    s_add_u32 s59, s60, 1
Lw_85:
    ds_read_b32 v15, v0 offset:17512
    s_waitcnt lgkmcnt(0)
    v_cmp_ne_u32 vcc, s59, v15
    s_cbranch_vccnz Lw_85
    ds_read_b128 v[96:99], v4 offset:4096
    ds_read_b128 v[100:103], v4 offset:5120
    ds_read_b128 v[104:107], v4 offset:6144
    ds_read_b128 v[108:111], v4 offset:7168
    s_waitcnt lgkmcnt(0)
    v_pk_add_f32 v[16:17], v[16:17], v[96:97]
    v_pk_add_f32 v[18:19], v[18:19], v[98:99]
    v_pk_add_f32 v[20:21], v[20:21], v[100:101]
    v_pk_add_f32 v[22:23], v[22:23], v[102:103]
    v_pk_add_f32 v[24:25], v[24:25], v[104:105]
    v_pk_add_f32 v[26:27], v[26:27], v[106:107]
    v_pk_add_f32 v[28:29], v[28:29], v[108:109]
    v_pk_add_f32 v[30:31], v[30:31], v[110:111]
    v_cvt_pk_bf16_f32 v64, v16, v17
    v_cvt_pk_bf16_f32 v66, v20, v21
    v_cvt_pk_bf16_f32 v65, v18, v19
    v_cvt_pk_bf16_f32 v67, v22, v23
    v_cvt_pk_bf16_f32 v68, v24, v25
    v_cvt_pk_bf16_f32 v70, v28, v29
    v_cvt_pk_bf16_f32 v69, v26, v27
    v_cvt_pk_bf16_f32 v71, v30, v31
    s_nop 1
    v_permlane16_swap_b32 v64, v66
    v_permlane16_swap_b32 v65, v67
    v_permlane16_swap_b32 v68, v70
    v_permlane16_swap_b32 v69, v71
    s_mov_b32 s51, 0x8000
    buffer_store_dwordx4 v[64:67], v5, s[28:31], 0 offen offset:0 sc1
    buffer_store_dwordx4 v[68:71], v5, s[28:31], 0 offen offset:64 sc1
    s_branch L_fin
L_c3_p1:
    ds_write_b128 v4, v[16:19] offset:4096
    ds_write_b128 v4, v[20:23] offset:5120
    ds_write_b128 v4, v[24:27] offset:6144
    ds_write_b128 v4, v[28:31] offset:7168
    s_add_u32 s58, s60, 1
    v_mov_b32 v14, s58
    ds_write_b32 v0, v14 offset:17512
    s_add_u32 s59, s60, 1
Lw_86:
    ds_read_b32 v15, v0 offset:17504
    s_waitcnt lgkmcnt(0)
    v_cmp_ne_u32 vcc, s59, v15
    s_cbranch_vccnz Lw_86
    ds_read_b128 v[96:99], v4 offset:0
    ds_read_b128 v[100:103], v4 offset:1024
    ds_read_b128 v[104:107], v4 offset:2048
    ds_read_b128 v[108:111], v4 offset:3072
    s_waitcnt lgkmcnt(0)
    v_pk_add_f32 v[32:33], v[32:33], v[96:97]
    v_pk_add_f32 v[34:35], v[34:35], v[98:99]
    v_pk_add_f32 v[36:37], v[36:37], v[100:101]
    v_pk_add_f32 v[38:39], v[38:39], v[102:103]
    v_pk_add_f32 v[40:41], v[40:41], v[104:105]
    v_pk_add_f32 v[42:43], v[42:43], v[106:107]
    v_pk_add_f32 v[44:45], v[44:45], v[108:109]
    v_pk_add_f32 v[46:47], v[46:47], v[110:111]
    v_cvt_pk_bf16_f32 v64, v32, v33
    v_cvt_pk_bf16_f32 v66, v36, v37
    v_cvt_pk_bf16_f32 v65, v34, v35
    v_cvt_pk_bf16_f32 v67, v38, v39
    v_cvt_pk_bf16_f32 v68, v40, v41
    v_cvt_pk_bf16_f32 v70, v44, v45
    v_cvt_pk_bf16_f32 v69, v42, v43
    v_cvt_pk_bf16_f32 v71, v46, v47
    s_nop 1
    v_permlane16_swap_b32 v64, v66
    v_permlane16_swap_b32 v65, v67
    v_permlane16_swap_b32 v68, v70
    v_permlane16_swap_b32 v69, v71
    s_mov_b32 s51, 0x8000
    buffer_store_dwordx4 v[64:67], v5, s[28:31], 0 offen offset:0 sc1
    buffer_store_dwordx4 v[68:71], v5, s[28:31], 0 offen offset:64 sc1
    s_branch L_fin
Ltg_3:
    v_mov_b32 v12, s60
    v_mov_b32 v13, s61
    v_mov_b32 v14, 0
    s_mov_b32 s58, s65
    s_waitcnt vmcnt(0)
    s_mov_b64 exec, 1
    s_add_u32 s59, s58, 0x40000
    buffer_store_dwordx2 v[12:13], v14, s[32:35], s59 offen
    buffer_store_dwordx2 v[12:13], v14, s[32:35], s58 offen sc1
    s_mov_b64 exec, -1
    s_mov_b32 s74, 1
    s_mov_b32 s76, 0
    s_branch Ltb_4
Ltg_5:
    v_mov_b32 v12, s60
    v_mov_b32 v13, s61
    v_mov_b32 v14, 0
    s_mov_b32 s58, s65
    s_waitcnt vmcnt(0)
    s_mov_b64 exec, 1
    s_add_u32 s59, s58, 0x40000
    buffer_store_dwordx2 v[12:13], v14, s[32:35], s59 offen
    buffer_store_dwordx2 v[12:13], v14, s[32:35], s58 offen sc1
    s_mov_b64 exec, -1
    s_mov_b32 s74, 1
    s_mov_b32 s76, 0
    s_branch Ltb_6
Ltg_7:
    v_mov_b32 v12, s60
    v_mov_b32 v13, s61
    v_mov_b32 v14, 0
    s_mov_b32 s58, s65
    s_waitcnt vmcnt(0)
    s_mov_b64 exec, 1
    s_add_u32 s59, s58, 0x40000
    buffer_store_dwordx2 v[12:13], v14, s[32:35], s59 offen
    buffer_store_dwordx2 v[12:13], v14, s[32:35], s58 offen sc1
    s_mov_b64 exec, -1
    s_mov_b32 s74, 1
    s_mov_b32 s76, 0
    s_branch Ltb_8
Ltg_10:
    v_mov_b32 v12, s60
    v_mov_b32 v13, s61
    v_mov_b32 v14, 0
    s_mov_b32 s58, s65
    s_waitcnt vmcnt(0)
    s_mov_b64 exec, 1
    s_add_u32 s59, s58, 0x40000
    buffer_store_dwordx2 v[12:13], v14, s[32:35], s59 offen
    buffer_store_dwordx2 v[12:13], v14, s[32:35], s58 offen sc1
    s_mov_b64 exec, -1
    s_mov_b32 s74, 1
    s_mov_b32 s76, 0
    s_branch Ltb_11
Ltg_12:
    v_mov_b32 v12, s60
    v_mov_b32 v13, s61
    v_mov_b32 v14, 0
    s_mov_b32 s58, s65
    s_waitcnt vmcnt(0)
    s_mov_b64 exec, 1
    s_add_u32 s59, s58, 0x40000
    buffer_store_dwordx2 v[12:13], v14, s[32:35], s59 offen
    buffer_store_dwordx2 v[12:13], v14, s[32:35], s58 offen sc1
    s_mov_b64 exec, -1
    s_mov_b32 s74, 1
    s_mov_b32 s76, 0
    s_branch Ltb_13
Lrg_14:
    buffer_load_dwordx4 v[112:115], v3, s[32:35], s68 offen offset:0 sc1
    buffer_load_dwordx4 v[116:119], v3, s[32:35], s68 offen offset:1024 sc1
    buffer_load_dwordx4 v[120:123], v3, s[32:35], s68 offen offset:2048 sc1
    buffer_load_dwordx4 v[124:127], v3, s[32:35], s68 offen offset:3072 sc1
    s_add_u32 s58, s68, 4096
    buffer_load_dwordx4 v[128:131], v3, s[32:35], s58 offen offset:0 sc1
    buffer_load_dwordx4 v[132:135], v3, s[32:35], s58 offen offset:1024 sc1
    buffer_load_dwordx4 v[136:139], v3, s[32:35], s58 offen offset:2048 sc1
    buffer_load_dwordx4 v[140:143], v3, s[32:35], s58 offen offset:3072 sc1
    s_mov_b32 s76, -1
    s_branch Lrb_15
Lrg_16:
    buffer_load_dwordx4 v[112:115], v3, s[32:35], s68 offen offset:0 sc1
    buffer_load_dwordx4 v[116:119], v3, s[32:35], s68 offen offset:1024 sc1
    buffer_load_dwordx4 v[120:123], v3, s[32:35], s68 offen offset:2048 sc1
    buffer_load_dwordx4 v[124:127], v3, s[32:35], s68 offen offset:3072 sc1
    s_add_u32 s58, s68, 4096
    buffer_load_dwordx4 v[128:131], v3, s[32:35], s58 offen offset:0 sc1
    buffer_load_dwordx4 v[132:135], v3, s[32:35], s58 offen offset:1024 sc1
    buffer_load_dwordx4 v[136:139], v3, s[32:35], s58 offen offset:2048 sc1
    buffer_load_dwordx4 v[140:143], v3, s[32:35], s58 offen offset:3072 sc1
    s_mov_b32 s76, -1
    s_branch Lrb_17
Lrg_18:
    buffer_load_dwordx4 v[112:115], v3, s[32:35], s68 offen offset:0 sc1
    buffer_load_dwordx4 v[116:119], v3, s[32:35], s68 offen offset:1024 sc1
    buffer_load_dwordx4 v[120:123], v3, s[32:35], s68 offen offset:2048 sc1
    buffer_load_dwordx4 v[124:127], v3, s[32:35], s68 offen offset:3072 sc1
    s_add_u32 s58, s68, 4096
    buffer_load_dwordx4 v[128:131], v3, s[32:35], s58 offen offset:0 sc1
    buffer_load_dwordx4 v[132:135], v3, s[32:35], s58 offen offset:1024 sc1
    buffer_load_dwordx4 v[136:139], v3, s[32:35], s58 offen offset:2048 sc1
    buffer_load_dwordx4 v[140:143], v3, s[32:35], s58 offen offset:3072 sc1
    s_mov_b32 s76, -1
    s_branch Lrb_19
Ltg_20:
    v_mov_b32 v12, s60
    v_mov_b32 v13, s61
    v_mov_b32 v14, 0
    s_mov_b32 s58, s65
    s_waitcnt vmcnt(0)
    s_mov_b64 exec, 1
    s_add_u32 s59, s58, 0x40000
    buffer_store_dwordx2 v[12:13], v14, s[32:35], s59 offen
    buffer_store_dwordx2 v[12:13], v14, s[32:35], s58 offen sc1
    s_mov_b64 exec, -1
    s_mov_b32 s74, 1
    s_mov_b32 s76, 0
    s_branch Ltb_21
Lrg_22:
    s_add_u32 s59, s60, 1
Lw_87:
    ds_read_b32 v11, v0 offset:17472
    s_waitcnt lgkmcnt(0)
    v_cmp_ne_u32 vcc, s59, v11
    s_cbranch_vccnz Lw_87
    buffer_load_dwordx4 v[112:115], v3, s[32:35], s68 offen offset:0 sc1
    buffer_load_dwordx4 v[116:119], v3, s[32:35], s68 offen offset:1024 sc1
    buffer_load_dwordx4 v[120:123], v3, s[32:35], s68 offen offset:2048 sc1
    buffer_load_dwordx4 v[124:127], v3, s[32:35], s68 offen offset:3072 sc1
    s_add_u32 s58, s68, 4096
    buffer_load_dwordx4 v[128:131], v3, s[32:35], s58 offen offset:0 sc1
    buffer_load_dwordx4 v[132:135], v3, s[32:35], s58 offen offset:1024 sc1
    buffer_load_dwordx4 v[136:139], v3, s[32:35], s58 offen offset:2048 sc1
    buffer_load_dwordx4 v[140:143], v3, s[32:35], s58 offen offset:3072 sc1
    s_mov_b32 s76, -1
    s_branch Lrb_23
Lcg_24:
    s_add_u32 s59, s60, 1
Lw_88:
    ds_read_b32 v1, v0 offset:17432
    s_waitcnt lgkmcnt(0)
    v_cmp_ne_u32 vcc, s59, v1
    s_cbranch_vccnz Lw_88
    s_branch Lcb_25
Lcg_26:
    s_add_u32 s59, s60, 1
Lw_89:
    ds_read_b32 v1, v0 offset:17448
    s_waitcnt lgkmcnt(0)
    v_cmp_ne_u32 vcc, s59, v1
    s_cbranch_vccnz Lw_89
    s_branch Lcb_27
Ltg_28:
    v_mov_b32 v48, s60
    v_mov_b32 v49, s61
    v_mov_b32 v50, 0
    s_add_u32 s58, s67, 2048
    s_waitcnt vmcnt(0)
    s_mov_b64 exec, 1
    buffer_store_dwordx2 v[48:49], v50, s[32:35], s58 offen sc1
    s_mov_b64 exec, -1
    s_mov_b32 s75, 1
    s_branch Ltb_29
Lcg_30:
    s_add_u32 s59, s60, 1
Lw_90:
    ds_read_b32 v1, v0 offset:17464
    s_waitcnt lgkmcnt(0)
    v_cmp_ne_u32 vcc, s59, v1
    s_cbranch_vccnz Lw_90
    s_branch Lcb_31
Ltg_32:
    v_mov_b32 v48, s60
    v_mov_b32 v49, s61
    v_mov_b32 v50, 0
    s_add_u32 s58, s67, 2048
    s_waitcnt vmcnt(0)
    s_mov_b64 exec, 1
    buffer_store_dwordx2 v[48:49], v50, s[32:35], s58 offen sc1
    s_mov_b64 exec, -1
    s_mov_b32 s75, 1
    s_branch Ltb_33
Ltg_34:
    v_mov_b32 v48, s60
    v_mov_b32 v49, s61
    v_mov_b32 v50, 0
    s_add_u32 s58, s67, 2048
    s_waitcnt vmcnt(0)
    s_mov_b64 exec, 1
    buffer_store_dwordx2 v[48:49], v50, s[32:35], s58 offen sc1
    s_mov_b64 exec, -1
    s_mov_b32 s75, 1
    s_branch Ltb_35
Lcg_36:
    s_add_u32 s59, s60, 2
Lw_91:
    ds_read_b32 v1, v0 offset:17448
    s_waitcnt lgkmcnt(0)
    v_cmp_ne_u32 vcc, s59, v1
    s_cbranch_vccnz Lw_91
    s_branch Lcb_37
Ltg_38:
    v_mov_b32 v48, s60
    v_mov_b32 v49, s61
    v_mov_b32 v50, 0
    s_add_u32 s58, s67, 2048
    s_waitcnt vmcnt(0)
    s_mov_b64 exec, 1
    buffer_store_dwordx2 v[48:49], v50, s[32:35], s58 offen sc1
    s_mov_b64 exec, -1
    s_mov_b32 s75, 1
    s_branch Ltb_39
Ltg_40:
    v_mov_b32 v32, s60
    v_mov_b32 v33, s61
    v_mov_b32 v34, 0
    s_add_u32 s58, s67, 1024
    s_waitcnt vmcnt(0)
    s_mov_b64 exec, 1
    buffer_store_dwordx2 v[32:33], v34, s[32:35], s58 offen sc1
    s_mov_b64 exec, -1
    s_mov_b32 s75, 1
    s_branch Ltb_41
Ltg_44:
    v_mov_b32 v12, s60
    v_mov_b32 v13, s61
    v_mov_b32 v14, 0
    s_mov_b32 s58, s65
    s_waitcnt vmcnt(0)
    s_mov_b64 exec, 1
    s_add_u32 s59, s58, 0x40000
    buffer_store_dwordx2 v[12:13], v14, s[32:35], s59 offen
    buffer_store_dwordx2 v[12:13], v14, s[32:35], s58 offen sc1
    s_mov_b64 exec, -1
    s_mov_b32 s74, 1
    s_mov_b32 s76, 0
    s_branch Ltb_45
Ltg_46:
    v_mov_b32 v12, s60
    v_mov_b32 v13, s61
    v_mov_b32 v14, 0
    s_mov_b32 s58, s65
    s_waitcnt vmcnt(0)
    s_mov_b64 exec, 1
    s_add_u32 s59, s58, 0x40000
    buffer_store_dwordx2 v[12:13], v14, s[32:35], s59 offen
    buffer_store_dwordx2 v[12:13], v14, s[32:35], s58 offen sc1
    s_mov_b64 exec, -1
    s_mov_b32 s74, 1
    s_mov_b32 s76, 0
    s_branch Ltb_47
Ltg_48:
    v_mov_b32 v12, s60
    v_mov_b32 v13, s61
    v_mov_b32 v14, 0
    s_mov_b32 s58, s65
    s_waitcnt vmcnt(0)
    s_mov_b64 exec, 1
    s_add_u32 s59, s58, 0x40000
    buffer_store_dwordx2 v[12:13], v14, s[32:35], s59 offen
    buffer_store_dwordx2 v[12:13], v14, s[32:35], s58 offen sc1
    s_mov_b64 exec, -1
    s_mov_b32 s74, 1
    s_mov_b32 s76, 0
    s_branch Ltb_49
Ltg_51:
    v_mov_b32 v12, s60
    v_mov_b32 v13, s61
    v_mov_b32 v14, 0
    s_mov_b32 s58, s65
    s_waitcnt vmcnt(0)
    s_mov_b64 exec, 1
    s_add_u32 s59, s58, 0x40000
    buffer_store_dwordx2 v[12:13], v14, s[32:35], s59 offen
    buffer_store_dwordx2 v[12:13], v14, s[32:35], s58 offen sc1
    s_mov_b64 exec, -1
    s_mov_b32 s74, 1
    s_mov_b32 s76, 0
    s_branch Ltb_52
Ltg_53:
    v_mov_b32 v12, s60
    v_mov_b32 v13, s61
    v_mov_b32 v14, 0
    s_mov_b32 s58, s65
    s_waitcnt vmcnt(0)
    s_mov_b64 exec, 1
    s_add_u32 s59, s58, 0x40000
    buffer_store_dwordx2 v[12:13], v14, s[32:35], s59 offen
    buffer_store_dwordx2 v[12:13], v14, s[32:35], s58 offen sc1
    s_mov_b64 exec, -1
    s_mov_b32 s74, 1
    s_mov_b32 s76, 0
    s_branch Ltb_54
Lrg_56:
    s_add_u32 s59, s60, 1
Lw_92:
    ds_read_b32 v11, v0 offset:17472
    s_waitcnt lgkmcnt(0)
    v_cmp_ne_u32 vcc, s59, v11
    s_cbranch_vccnz Lw_92
    buffer_load_dwordx4 v[112:115], v3, s[32:35], s68 offen offset:0 sc1
    buffer_load_dwordx4 v[116:119], v3, s[32:35], s68 offen offset:1024 sc1
    buffer_load_dwordx4 v[120:123], v3, s[32:35], s68 offen offset:2048 sc1
    buffer_load_dwordx4 v[124:127], v3, s[32:35], s68 offen offset:3072 sc1
    s_add_u32 s58, s68, 4096
    buffer_load_dwordx4 v[128:131], v3, s[32:35], s58 offen offset:0 sc1
    buffer_load_dwordx4 v[132:135], v3, s[32:35], s58 offen offset:1024 sc1
    buffer_load_dwordx4 v[136:139], v3, s[32:35], s58 offen offset:2048 sc1
    buffer_load_dwordx4 v[140:143], v3, s[32:35], s58 offen offset:3072 sc1
    s_mov_b32 s76, -1
    s_branch Lrb_57
Lcg_58:
    s_add_u32 s59, s60, 1
Lw_93:
    ds_read_b32 v1, v0 offset:17440
    s_waitcnt lgkmcnt(0)
    v_cmp_ne_u32 vcc, s59, v1
    s_cbranch_vccnz Lw_93
    s_branch Lcb_59
Ltg_60:
    v_mov_b32 v64, s60
    v_mov_b32 v65, s61
    v_mov_b32 v66, 0
    s_add_u32 s58, s67, 3072
    s_waitcnt vmcnt(0)
    s_mov_b64 exec, 1
    buffer_store_dwordx2 v[64:65], v66, s[32:35], s58 offen sc1
    s_mov_b64 exec, -1
    s_mov_b32 s75, 1
    s_branch Ltb_61
Ltg_62:
    v_mov_b32 v64, s60
    v_mov_b32 v65, s61
    v_mov_b32 v66, 0
    s_add_u32 s58, s67, 3072
    s_waitcnt vmcnt(0)
    s_mov_b64 exec, 1
    buffer_store_dwordx2 v[64:65], v66, s[32:35], s58 offen sc1
    s_mov_b64 exec, -1
    s_mov_b32 s75, 1
    s_branch Ltb_63
Lcg_64:
    s_add_u32 s59, s60, 1
Lw_94:
    ds_read_b32 v1, v0 offset:17456
    s_waitcnt lgkmcnt(0)
    v_cmp_ne_u32 vcc, s59, v1
    s_cbranch_vccnz Lw_94
    s_branch Lcb_65
Ltg_66:
    v_mov_b32 v64, s60
    v_mov_b32 v65, s61
    v_mov_b32 v66, 0
    s_add_u32 s58, s67, 3072
    s_waitcnt vmcnt(0)
    s_mov_b64 exec, 1
    buffer_store_dwordx2 v[64:65], v66, s[32:35], s58 offen sc1
    s_mov_b64 exec, -1
    s_mov_b32 s75, 1
    s_branch Ltb_67
Ltg_68:
    v_mov_b32 v64, s60
    v_mov_b32 v65, s61
    v_mov_b32 v66, 0
    s_add_u32 s58, s67, 3072
    s_waitcnt vmcnt(0)
    s_mov_b64 exec, 1
    buffer_store_dwordx2 v[64:65], v66, s[32:35], s58 offen sc1
    s_mov_b64 exec, -1
    s_mov_b32 s75, 1
    s_branch Ltb_69
Ltg_70:
    v_mov_b32 v64, s60
    v_mov_b32 v65, s61
    v_mov_b32 v66, 0
    s_add_u32 s58, s67, 3072
    s_waitcnt vmcnt(0)
    s_mov_b64 exec, 1
    buffer_store_dwordx2 v[64:65], v66, s[32:35], s58 offen sc1
    s_mov_b64 exec, -1
    s_mov_b32 s75, 1
    s_branch Ltb_71
Lcg_72:
    s_add_u32 s59, s60, 2
Lw_95:
    ds_read_b32 v1, v0 offset:17440
    s_waitcnt lgkmcnt(0)
    v_cmp_ne_u32 vcc, s59, v1
    s_cbranch_vccnz Lw_95
    s_branch Lcb_73
Ltg_74:
    v_mov_b32 v64, s60
    v_mov_b32 v65, s61
    v_mov_b32 v66, 0
    s_add_u32 s58, s67, 3072
    s_waitcnt vmcnt(0)
    s_mov_b64 exec, 1
    buffer_store_dwordx2 v[64:65], v66, s[32:35], s58 offen sc1
    s_mov_b64 exec, -1
    s_mov_b32 s75, 1
    s_branch Ltb_75
Ltg_76:
    v_mov_b32 v16, s60
    v_mov_b32 v17, s61
    v_mov_b32 v18, 0
    s_add_u32 s58, s67, 0
    s_waitcnt vmcnt(0)
    s_mov_b64 exec, 1
    buffer_store_dwordx2 v[16:17], v18, s[32:35], s58 offen sc1
    s_mov_b64 exec, -1
    s_mov_b32 s75, 1
    s_branch Ltb_77
Lslow_42:
    s_bitcmp1_b32 s63, 0
    s_cbranch_scc0 Lnf_96
    s_lshl_b32 s68, s40, 2
    s_add_u32 s68, s68, 2
    s_lshl_b32 s69, s62, 18
    v_and_b32 v4, 31, v2
    v_lshrrev_b32 v5, 5, v2
    v_lshlrev_b32 v5, 2, v5
    v_sub_u32 v4, v4, v5
    s_sub_u32 s52, s68, 8
    s_max_i32 s52, s52, 0
    v_mov_b32 v96, 0xf149f2ca
    v_mov_b32 v99, 0xf149f2ca
    v_mov_b32 v97, 0
    v_mov_b32 v80, 0
    v_mov_b32 v81, 0
    v_mov_b32 v82, 0
    v_mov_b32 v83, 0
    v_mov_b32 v84, 0
    v_mov_b32 v85, 0
    v_mov_b32 v86, 0
    v_mov_b32 v87, 0
    v_mov_b32 v88, 0
    v_mov_b32 v89, 0
    v_mov_b32 v90, 0
    v_mov_b32 v91, 0
    v_mov_b32 v92, 0
    v_mov_b32 v93, 0
    v_mov_b32 v94, 0
    v_mov_b32 v95, 0
    s_movk_i32 s57, 256
    s_mov_b32 s53, s52
Lat_97:
    s_lshl_b32 s54, s53, 12
    s_add_u32 s54, s54, s69
    buffer_load_dwordx4 v[32:35], v3, s[32:35], s54 offen sc1
    buffer_load_dwordx4 v[36:39], v3, s[32:35], s54 offen offset:1024 sc1
    s_sub_u32 s55, s68, s53
    s_lshl_b32 s55, s55, 5
    v_add_u32 v100, s55, v4
    s_waitcnt vmcnt(0)
    v_mfma_f32_32x32x16_bf16 v[48:63], v[32:35], v[160:163], 0
    v_mfma_f32_32x32x16_bf16 v[48:63], v[36:39], v[164:167], v[48:63]
    s_nop 15
    v_subrev_u32 v98, 0, v100
    v_cmp_gt_u32 vcc, s57, v98
    s_nop 1
    v_cndmask_b32 v48, v99, v48, vcc
    v_max_f32 v96, v96, v48
    v_subrev_u32 v98, 1, v100
    v_cmp_gt_u32 vcc, s57, v98
    s_nop 1
    v_cndmask_b32 v49, v99, v49, vcc
    v_max_f32 v96, v96, v49
    v_subrev_u32 v98, 2, v100
    v_cmp_gt_u32 vcc, s57, v98
    s_nop 1
    v_cndmask_b32 v50, v99, v50, vcc
    v_max_f32 v96, v96, v50
    v_subrev_u32 v98, 3, v100
    v_cmp_gt_u32 vcc, s57, v98
    s_nop 1
    v_cndmask_b32 v51, v99, v51, vcc
    v_max_f32 v96, v96, v51
    v_subrev_u32 v98, 8, v100
    v_cmp_gt_u32 vcc, s57, v98
    s_nop 1
    v_cndmask_b32 v52, v99, v52, vcc
    v_max_f32 v96, v96, v52
    v_subrev_u32 v98, 9, v100
    v_cmp_gt_u32 vcc, s57, v98
    s_nop 1
    v_cndmask_b32 v53, v99, v53, vcc
    v_max_f32 v96, v96, v53
    v_subrev_u32 v98, 10, v100
    v_cmp_gt_u32 vcc, s57, v98
    s_nop 1
    v_cndmask_b32 v54, v99, v54, vcc
    v_max_f32 v96, v96, v54
    v_subrev_u32 v98, 11, v100
    v_cmp_gt_u32 vcc, s57, v98
    s_nop 1
    v_cndmask_b32 v55, v99, v55, vcc
    v_max_f32 v96, v96, v55
    v_subrev_u32 v98, 16, v100
    v_cmp_gt_u32 vcc, s57, v98
    s_nop 1
    v_cndmask_b32 v56, v99, v56, vcc
    v_max_f32 v96, v96, v56
    v_subrev_u32 v98, 17, v100
    v_cmp_gt_u32 vcc, s57, v98
    s_nop 1
    v_cndmask_b32 v57, v99, v57, vcc
    v_max_f32 v96, v96, v57
    v_subrev_u32 v98, 18, v100
    v_cmp_gt_u32 vcc, s57, v98
    s_nop 1
    v_cndmask_b32 v58, v99, v58, vcc
    v_max_f32 v96, v96, v58
    v_subrev_u32 v98, 19, v100
    v_cmp_gt_u32 vcc, s57, v98
    s_nop 1
    v_cndmask_b32 v59, v99, v59, vcc
    v_max_f32 v96, v96, v59
    v_subrev_u32 v98, 24, v100
    v_cmp_gt_u32 vcc, s57, v98
    s_nop 1
    v_cndmask_b32 v60, v99, v60, vcc
    v_max_f32 v96, v96, v60
    v_subrev_u32 v98, 25, v100
    v_cmp_gt_u32 vcc, s57, v98
    s_nop 1
    v_cndmask_b32 v61, v99, v61, vcc
    v_max_f32 v96, v96, v61
    v_subrev_u32 v98, 26, v100
    v_cmp_gt_u32 vcc, s57, v98
    s_nop 1
    v_cndmask_b32 v62, v99, v62, vcc
    v_max_f32 v96, v96, v62
    v_subrev_u32 v98, 27, v100
    v_cmp_gt_u32 vcc, s57, v98
    s_nop 1
    v_cndmask_b32 v63, v99, v63, vcc
    v_max_f32 v96, v96, v63
    s_add_u32 s53, s53, 1
    s_cmp_le_u32 s53, s68
    s_cbranch_scc1 Lat_97
    v_mov_b32 v98, v96
    s_nop 1
    v_permlane32_swap_b32 v98, v96
    s_nop 1
    v_max_f32 v96, v96, v98
    s_mov_b32 s53, s52
Lat_98:
    s_lshl_b32 s54, s53, 12
    s_add_u32 s54, s54, s69
    buffer_load_dwordx4 v[32:35], v3, s[32:35], s54 offen sc1
    buffer_load_dwordx4 v[36:39], v3, s[32:35], s54 offen offset:1024 sc1
    buffer_load_dwordx4 v[40:43], v3, s[32:35], s54 offen offset:2048 sc1
    buffer_load_dwordx4 v[44:47], v3, s[32:35], s54 offen offset:3072 sc1
    s_sub_u32 s55, s68, s53
    s_lshl_b32 s55, s55, 5
    v_add_u32 v100, s55, v4
    s_waitcnt vmcnt(0)
    v_mfma_f32_32x32x16_bf16 v[48:63], v[32:35], v[160:163], 0
    v_mfma_f32_32x32x16_bf16 v[48:63], v[36:39], v[164:167], v[48:63]
    s_nop 15
    v_subrev_u32 v98, 0, v100
    v_cmp_gt_u32 vcc, s57, v98
    s_nop 1
    v_cndmask_b32 v48, v99, v48, vcc
    v_sub_f32 v48, v48, v96
    v_exp_f32 v48, v48
    s_nop 0
    v_add_f32 v97, v97, v48
    v_subrev_u32 v98, 1, v100
    v_cmp_gt_u32 vcc, s57, v98
    s_nop 1
    v_cndmask_b32 v49, v99, v49, vcc
    v_sub_f32 v49, v49, v96
    v_exp_f32 v49, v49
    s_nop 0
    v_add_f32 v97, v97, v49
    v_subrev_u32 v98, 2, v100
    v_cmp_gt_u32 vcc, s57, v98
    s_nop 1
    v_cndmask_b32 v50, v99, v50, vcc
    v_sub_f32 v50, v50, v96
    v_exp_f32 v50, v50
    s_nop 0
    v_add_f32 v97, v97, v50
    v_subrev_u32 v98, 3, v100
    v_cmp_gt_u32 vcc, s57, v98
    s_nop 1
    v_cndmask_b32 v51, v99, v51, vcc
    v_sub_f32 v51, v51, v96
    v_exp_f32 v51, v51
    s_nop 0
    v_add_f32 v97, v97, v51
    v_subrev_u32 v98, 8, v100
    v_cmp_gt_u32 vcc, s57, v98
    s_nop 1
    v_cndmask_b32 v52, v99, v52, vcc
    v_sub_f32 v52, v52, v96
    v_exp_f32 v52, v52
    s_nop 0
    v_add_f32 v97, v97, v52
    v_subrev_u32 v98, 9, v100
    v_cmp_gt_u32 vcc, s57, v98
    s_nop 1
    v_cndmask_b32 v53, v99, v53, vcc
    v_sub_f32 v53, v53, v96
    v_exp_f32 v53, v53
    s_nop 0
    v_add_f32 v97, v97, v53
    v_subrev_u32 v98, 10, v100
    v_cmp_gt_u32 vcc, s57, v98
    s_nop 1
    v_cndmask_b32 v54, v99, v54, vcc
    v_sub_f32 v54, v54, v96
    v_exp_f32 v54, v54
    s_nop 0
    v_add_f32 v97, v97, v54
    v_subrev_u32 v98, 11, v100
    v_cmp_gt_u32 vcc, s57, v98
    s_nop 1
    v_cndmask_b32 v55, v99, v55, vcc
    v_sub_f32 v55, v55, v96
    v_exp_f32 v55, v55
    s_nop 0
    v_add_f32 v97, v97, v55
    v_subrev_u32 v98, 16, v100
    v_cmp_gt_u32 vcc, s57, v98
    s_nop 1
    v_cndmask_b32 v56, v99, v56, vcc
    v_sub_f32 v56, v56, v96
    v_exp_f32 v56, v56
    s_nop 0
    v_add_f32 v97, v97, v56
    v_subrev_u32 v98, 17, v100
    v_cmp_gt_u32 vcc, s57, v98
    s_nop 1
    v_cndmask_b32 v57, v99, v57, vcc
    v_sub_f32 v57, v57, v96
    v_exp_f32 v57, v57
    s_nop 0
    v_add_f32 v97, v97, v57
    v_subrev_u32 v98, 18, v100
    v_cmp_gt_u32 vcc, s57, v98
    s_nop 1
    v_cndmask_b32 v58, v99, v58, vcc
    v_sub_f32 v58, v58, v96
    v_exp_f32 v58, v58
    s_nop 0
    v_add_f32 v97, v97, v58
    v_subrev_u32 v98, 19, v100
    v_cmp_gt_u32 vcc, s57, v98
    s_nop 1
    v_cndmask_b32 v59, v99, v59, vcc
    v_sub_f32 v59, v59, v96
    v_exp_f32 v59, v59
    s_nop 0
    v_add_f32 v97, v97, v59
    v_subrev_u32 v98, 24, v100
    v_cmp_gt_u32 vcc, s57, v98
    s_nop 1
    v_cndmask_b32 v60, v99, v60, vcc
    v_sub_f32 v60, v60, v96
    v_exp_f32 v60, v60
    s_nop 0
    v_add_f32 v97, v97, v60
    v_subrev_u32 v98, 25, v100
    v_cmp_gt_u32 vcc, s57, v98
    s_nop 1
    v_cndmask_b32 v61, v99, v61, vcc
    v_sub_f32 v61, v61, v96
    v_exp_f32 v61, v61
    s_nop 0
    v_add_f32 v97, v97, v61
    v_subrev_u32 v98, 26, v100
    v_cmp_gt_u32 vcc, s57, v98
    s_nop 1
    v_cndmask_b32 v62, v99, v62, vcc
    v_sub_f32 v62, v62, v96
    v_exp_f32 v62, v62
    s_nop 0
    v_add_f32 v97, v97, v62
    v_subrev_u32 v98, 27, v100
    v_cmp_gt_u32 vcc, s57, v98
    s_nop 1
    v_cndmask_b32 v63, v99, v63, vcc
    v_sub_f32 v63, v63, v96
    v_exp_f32 v63, v63
    s_nop 0
    v_add_f32 v97, v97, v63
    v_cvt_pk_bf16_f32 v64, v48, v49
    v_cvt_pk_bf16_f32 v65, v50, v51
    v_cvt_pk_bf16_f32 v66, v52, v53
    v_cvt_pk_bf16_f32 v67, v54, v55
    v_cvt_pk_bf16_f32 v68, v56, v57
    v_cvt_pk_bf16_f32 v69, v58, v59
    v_cvt_pk_bf16_f32 v70, v60, v61
    v_cvt_pk_bf16_f32 v71, v62, v63
    s_nop 1
    v_mfma_f32_32x32x16_bf16 v[80:95], v[40:43], v[64:67], v[80:95]
    v_mfma_f32_32x32x16_bf16 v[80:95], v[44:47], v[68:71], v[80:95]
    s_add_u32 s53, s53, 1
    s_cmp_le_u32 s53, s68
    s_cbranch_scc1 Lat_98
    v_mov_b32 v98, v97
    s_nop 1
    v_permlane32_swap_b32 v98, v97
    s_nop 1
    v_add_f32 v97, v97, v98
    v_rcp_f32 v97, v97
    s_nop 15
    v_mul_f32 v80, v80, v97
    v_mul_f32 v81, v81, v97
    v_mul_f32 v82, v82, v97
    v_mul_f32 v83, v83, v97
    v_mul_f32 v84, v84, v97
    v_mul_f32 v85, v85, v97
    v_mul_f32 v86, v86, v97
    v_mul_f32 v87, v87, v97
    v_mul_f32 v88, v88, v97
    v_mul_f32 v89, v89, v97
    v_mul_f32 v90, v90, v97
    v_mul_f32 v91, v91, v97
    v_mul_f32 v92, v92, v97
    v_mul_f32 v93, v93, v97
    v_mul_f32 v94, v94, v97
    v_mul_f32 v95, v95, v97
    v_cvt_pk_bf16_f32 v24, v80, v81
    v_cvt_pk_bf16_f32 v25, v82, v83
    v_cvt_pk_bf16_f32 v26, v84, v85
    v_cvt_pk_bf16_f32 v27, v86, v87
    v_cvt_pk_bf16_f32 v28, v88, v89
    v_cvt_pk_bf16_f32 v29, v90, v91
    v_cvt_pk_bf16_f32 v30, v92, v93
    v_cvt_pk_bf16_f32 v31, v94, v95
    v_and_b32 v102, 15, v2
    v_lshlrev_b32 v102, 4, v102
    v_bfe_u32 v103, v2, 4, 1
    v_lshl_add_u32 v102, v103, 10, v102
    v_lshrrev_b32 v103, 5, v2
    v_lshl_add_u32 v102, v103, 8, v102
    s_add_u32 s58, s66, 131072
    buffer_store_dwordx4 v[24:27], v102, s[32:35], s58 offen sc1
    buffer_store_dwordx4 v[28:31], v102, s[32:35], s58 offen offset:512 sc1
    v_mov_b32 v16, s60
    v_mov_b32 v17, s61
    v_mov_b32 v18, 0
    s_add_u32 s58, s67, 2048
    s_waitcnt vmcnt(0)
    s_mov_b64 exec, 1
    buffer_store_dwordx2 v[16:17], v18, s[32:35], s58 offen sc1
    s_mov_b64 exec, -1
Lskf_99:
Lnf_96:
    s_bitcmp1_b32 s63, 1
    s_cbranch_scc0 Lnf_100
    s_lshl_b32 s68, s40, 2
    s_add_u32 s68, s68, 1
    s_lshl_b32 s69, s62, 18
    v_and_b32 v4, 31, v2
    v_lshrrev_b32 v5, 5, v2
    v_lshlrev_b32 v5, 2, v5
    v_sub_u32 v4, v4, v5
    s_sub_u32 s52, s68, 8
    s_max_i32 s52, s52, 0
    v_mov_b32 v96, 0xf149f2ca
    v_mov_b32 v99, 0xf149f2ca
    v_mov_b32 v97, 0
    v_mov_b32 v80, 0
    v_mov_b32 v81, 0
    v_mov_b32 v82, 0
    v_mov_b32 v83, 0
    v_mov_b32 v84, 0
    v_mov_b32 v85, 0
    v_mov_b32 v86, 0
    v_mov_b32 v87, 0
    v_mov_b32 v88, 0
    v_mov_b32 v89, 0
    v_mov_b32 v90, 0
    v_mov_b32 v91, 0
    v_mov_b32 v92, 0
    v_mov_b32 v93, 0
    v_mov_b32 v94, 0
    v_mov_b32 v95, 0
    s_movk_i32 s57, 256
    s_mov_b32 s53, s52
Lat_101:
    s_lshl_b32 s54, s53, 12
    s_add_u32 s54, s54, s69
    buffer_load_dwordx4 v[32:35], v3, s[32:35], s54 offen sc1
    buffer_load_dwordx4 v[36:39], v3, s[32:35], s54 offen offset:1024 sc1
    s_sub_u32 s55, s68, s53
    s_lshl_b32 s55, s55, 5
    v_add_u32 v100, s55, v4
    s_waitcnt vmcnt(0)
    v_mfma_f32_32x32x16_bf16 v[48:63], v[32:35], v[152:155], 0
    v_mfma_f32_32x32x16_bf16 v[48:63], v[36:39], v[156:159], v[48:63]
    s_nop 15
    v_subrev_u32 v98, 0, v100
    v_cmp_gt_u32 vcc, s57, v98
    s_nop 1
    v_cndmask_b32 v48, v99, v48, vcc
    v_max_f32 v96, v96, v48
    v_subrev_u32 v98, 1, v100
    v_cmp_gt_u32 vcc, s57, v98
    s_nop 1
    v_cndmask_b32 v49, v99, v49, vcc
    v_max_f32 v96, v96, v49
    v_subrev_u32 v98, 2, v100
    v_cmp_gt_u32 vcc, s57, v98
    s_nop 1
    v_cndmask_b32 v50, v99, v50, vcc
    v_max_f32 v96, v96, v50
    v_subrev_u32 v98, 3, v100
    v_cmp_gt_u32 vcc, s57, v98
    s_nop 1
    v_cndmask_b32 v51, v99, v51, vcc
    v_max_f32 v96, v96, v51
    v_subrev_u32 v98, 8, v100
    v_cmp_gt_u32 vcc, s57, v98
    s_nop 1
    v_cndmask_b32 v52, v99, v52, vcc
    v_max_f32 v96, v96, v52
    v_subrev_u32 v98, 9, v100
    v_cmp_gt_u32 vcc, s57, v98
    s_nop 1
    v_cndmask_b32 v53, v99, v53, vcc
    v_max_f32 v96, v96, v53
    v_subrev_u32 v98, 10, v100
    v_cmp_gt_u32 vcc, s57, v98
    s_nop 1
    v_cndmask_b32 v54, v99, v54, vcc
    v_max_f32 v96, v96, v54
    v_subrev_u32 v98, 11, v100
    v_cmp_gt_u32 vcc, s57, v98
    s_nop 1
    v_cndmask_b32 v55, v99, v55, vcc
    v_max_f32 v96, v96, v55
    v_subrev_u32 v98, 16, v100
    v_cmp_gt_u32 vcc, s57, v98
    s_nop 1
    v_cndmask_b32 v56, v99, v56, vcc
    v_max_f32 v96, v96, v56
    v_subrev_u32 v98, 17, v100
    v_cmp_gt_u32 vcc, s57, v98
    s_nop 1
    v_cndmask_b32 v57, v99, v57, vcc
    v_max_f32 v96, v96, v57
    v_subrev_u32 v98, 18, v100
    v_cmp_gt_u32 vcc, s57, v98
    s_nop 1
    v_cndmask_b32 v58, v99, v58, vcc
    v_max_f32 v96, v96, v58
    v_subrev_u32 v98, 19, v100
    v_cmp_gt_u32 vcc, s57, v98
    s_nop 1
    v_cndmask_b32 v59, v99, v59, vcc
    v_max_f32 v96, v96, v59
    v_subrev_u32 v98, 24, v100
    v_cmp_gt_u32 vcc, s57, v98
    s_nop 1
    v_cndmask_b32 v60, v99, v60, vcc
    v_max_f32 v96, v96, v60
    v_subrev_u32 v98, 25, v100
    v_cmp_gt_u32 vcc, s57, v98
    s_nop 1
    v_cndmask_b32 v61, v99, v61, vcc
    v_max_f32 v96, v96, v61
    v_subrev_u32 v98, 26, v100
    v_cmp_gt_u32 vcc, s57, v98
    s_nop 1
    v_cndmask_b32 v62, v99, v62, vcc
    v_max_f32 v96, v96, v62
    v_subrev_u32 v98, 27, v100
    v_cmp_gt_u32 vcc, s57, v98
    s_nop 1
    v_cndmask_b32 v63, v99, v63, vcc
    v_max_f32 v96, v96, v63
    s_add_u32 s53, s53, 1
    s_cmp_le_u32 s53, s68
    s_cbranch_scc1 Lat_101
    v_mov_b32 v98, v96
    s_nop 1
    v_permlane32_swap_b32 v98, v96
    s_nop 1
    v_max_f32 v96, v96, v98
    s_mov_b32 s53, s52
Lat_102:
    s_lshl_b32 s54, s53, 12
    s_add_u32 s54, s54, s69
    buffer_load_dwordx4 v[32:35], v3, s[32:35], s54 offen sc1
    buffer_load_dwordx4 v[36:39], v3, s[32:35], s54 offen offset:1024 sc1
    buffer_load_dwordx4 v[40:43], v3, s[32:35], s54 offen offset:2048 sc1
    buffer_load_dwordx4 v[44:47], v3, s[32:35], s54 offen offset:3072 sc1
    s_sub_u32 s55, s68, s53
    s_lshl_b32 s55, s55, 5
    v_add_u32 v100, s55, v4
    s_waitcnt vmcnt(0)
    v_mfma_f32_32x32x16_bf16 v[48:63], v[32:35], v[152:155], 0
    v_mfma_f32_32x32x16_bf16 v[48:63], v[36:39], v[156:159], v[48:63]
    s_nop 15
    v_subrev_u32 v98, 0, v100
    v_cmp_gt_u32 vcc, s57, v98
    s_nop 1
    v_cndmask_b32 v48, v99, v48, vcc
    v_sub_f32 v48, v48, v96
    v_exp_f32 v48, v48
    s_nop 0
    v_add_f32 v97, v97, v48
    v_subrev_u32 v98, 1, v100
    v_cmp_gt_u32 vcc, s57, v98
    s_nop 1
    v_cndmask_b32 v49, v99, v49, vcc
    v_sub_f32 v49, v49, v96
    v_exp_f32 v49, v49
    s_nop 0
    v_add_f32 v97, v97, v49
    v_subrev_u32 v98, 2, v100
    v_cmp_gt_u32 vcc, s57, v98
    s_nop 1
    v_cndmask_b32 v50, v99, v50, vcc
    v_sub_f32 v50, v50, v96
    v_exp_f32 v50, v50
    s_nop 0
    v_add_f32 v97, v97, v50
    v_subrev_u32 v98, 3, v100
    v_cmp_gt_u32 vcc, s57, v98
    s_nop 1
    v_cndmask_b32 v51, v99, v51, vcc
    v_sub_f32 v51, v51, v96
    v_exp_f32 v51, v51
    s_nop 0
    v_add_f32 v97, v97, v51
    v_subrev_u32 v98, 8, v100
    v_cmp_gt_u32 vcc, s57, v98
    s_nop 1
    v_cndmask_b32 v52, v99, v52, vcc
    v_sub_f32 v52, v52, v96
    v_exp_f32 v52, v52
    s_nop 0
    v_add_f32 v97, v97, v52
    v_subrev_u32 v98, 9, v100
    v_cmp_gt_u32 vcc, s57, v98
    s_nop 1
    v_cndmask_b32 v53, v99, v53, vcc
    v_sub_f32 v53, v53, v96
    v_exp_f32 v53, v53
    s_nop 0
    v_add_f32 v97, v97, v53
    v_subrev_u32 v98, 10, v100
    v_cmp_gt_u32 vcc, s57, v98
    s_nop 1
    v_cndmask_b32 v54, v99, v54, vcc
    v_sub_f32 v54, v54, v96
    v_exp_f32 v54, v54
    s_nop 0
    v_add_f32 v97, v97, v54
    v_subrev_u32 v98, 11, v100
    v_cmp_gt_u32 vcc, s57, v98
    s_nop 1
    v_cndmask_b32 v55, v99, v55, vcc
    v_sub_f32 v55, v55, v96
    v_exp_f32 v55, v55
    s_nop 0
    v_add_f32 v97, v97, v55
    v_subrev_u32 v98, 16, v100
    v_cmp_gt_u32 vcc, s57, v98
    s_nop 1
    v_cndmask_b32 v56, v99, v56, vcc
    v_sub_f32 v56, v56, v96
    v_exp_f32 v56, v56
    s_nop 0
    v_add_f32 v97, v97, v56
    v_subrev_u32 v98, 17, v100
    v_cmp_gt_u32 vcc, s57, v98
    s_nop 1
    v_cndmask_b32 v57, v99, v57, vcc
    v_sub_f32 v57, v57, v96
    v_exp_f32 v57, v57
    s_nop 0
    v_add_f32 v97, v97, v57
    v_subrev_u32 v98, 18, v100
    v_cmp_gt_u32 vcc, s57, v98
    s_nop 1
    v_cndmask_b32 v58, v99, v58, vcc
    v_sub_f32 v58, v58, v96
    v_exp_f32 v58, v58
    s_nop 0
    v_add_f32 v97, v97, v58
    v_subrev_u32 v98, 19, v100
    v_cmp_gt_u32 vcc, s57, v98
    s_nop 1
    v_cndmask_b32 v59, v99, v59, vcc
    v_sub_f32 v59, v59, v96
    v_exp_f32 v59, v59
    s_nop 0
    v_add_f32 v97, v97, v59
    v_subrev_u32 v98, 24, v100
    v_cmp_gt_u32 vcc, s57, v98
    s_nop 1
    v_cndmask_b32 v60, v99, v60, vcc
    v_sub_f32 v60, v60, v96
    v_exp_f32 v60, v60
    s_nop 0
    v_add_f32 v97, v97, v60
    v_subrev_u32 v98, 25, v100
    v_cmp_gt_u32 vcc, s57, v98
    s_nop 1
    v_cndmask_b32 v61, v99, v61, vcc
    v_sub_f32 v61, v61, v96
    v_exp_f32 v61, v61
    s_nop 0
    v_add_f32 v97, v97, v61
    v_subrev_u32 v98, 26, v100
    v_cmp_gt_u32 vcc, s57, v98
    s_nop 1
    v_cndmask_b32 v62, v99, v62, vcc
    v_sub_f32 v62, v62, v96
    v_exp_f32 v62, v62
    s_nop 0
    v_add_f32 v97, v97, v62
    v_subrev_u32 v98, 27, v100
    v_cmp_gt_u32 vcc, s57, v98
    s_nop 1
    v_cndmask_b32 v63, v99, v63, vcc
    v_sub_f32 v63, v63, v96
    v_exp_f32 v63, v63
    s_nop 0
    v_add_f32 v97, v97, v63
    v_cvt_pk_bf16_f32 v64, v48, v49
    v_cvt_pk_bf16_f32 v65, v50, v51
    v_cvt_pk_bf16_f32 v66, v52, v53
    v_cvt_pk_bf16_f32 v67, v54, v55
    v_cvt_pk_bf16_f32 v68, v56, v57
    v_cvt_pk_bf16_f32 v69, v58, v59
    v_cvt_pk_bf16_f32 v70, v60, v61
    v_cvt_pk_bf16_f32 v71, v62, v63
    s_nop 1
    v_mfma_f32_32x32x16_bf16 v[80:95], v[40:43], v[64:67], v[80:95]
    v_mfma_f32_32x32x16_bf16 v[80:95], v[44:47], v[68:71], v[80:95]
    s_add_u32 s53, s53, 1
    s_cmp_le_u32 s53, s68
    s_cbranch_scc1 Lat_102
    v_mov_b32 v98, v97
    s_nop 1
    v_permlane32_swap_b32 v98, v97
    s_nop 1
    v_add_f32 v97, v97, v98
    v_rcp_f32 v97, v97
    s_nop 15
    v_mul_f32 v80, v80, v97
    v_mul_f32 v81, v81, v97
    v_mul_f32 v82, v82, v97
    v_mul_f32 v83, v83, v97
    v_mul_f32 v84, v84, v97
    v_mul_f32 v85, v85, v97
    v_mul_f32 v86, v86, v97
    v_mul_f32 v87, v87, v97
    v_mul_f32 v88, v88, v97
    v_mul_f32 v89, v89, v97
    v_mul_f32 v90, v90, v97
    v_mul_f32 v91, v91, v97
    v_mul_f32 v92, v92, v97
    v_mul_f32 v93, v93, v97
    v_mul_f32 v94, v94, v97
    v_mul_f32 v95, v95, v97
    v_cvt_pk_bf16_f32 v24, v80, v81
    v_cvt_pk_bf16_f32 v25, v82, v83
    v_cvt_pk_bf16_f32 v26, v84, v85
    v_cvt_pk_bf16_f32 v27, v86, v87
    v_cvt_pk_bf16_f32 v28, v88, v89
    v_cvt_pk_bf16_f32 v29, v90, v91
    v_cvt_pk_bf16_f32 v30, v92, v93
    v_cvt_pk_bf16_f32 v31, v94, v95
    v_and_b32 v102, 15, v2
    v_lshlrev_b32 v102, 4, v102
    v_bfe_u32 v103, v2, 4, 1
    v_lshl_add_u32 v102, v103, 10, v102
    v_lshrrev_b32 v103, 5, v2
    v_lshl_add_u32 v102, v103, 8, v102
    s_add_u32 s58, s66, 65536
    buffer_store_dwordx4 v[24:27], v102, s[32:35], s58 offen sc1
    buffer_store_dwordx4 v[28:31], v102, s[32:35], s58 offen offset:512 sc1
    v_mov_b32 v16, s60
    v_mov_b32 v17, s61
    v_mov_b32 v18, 0
    s_add_u32 s58, s67, 1024
    s_waitcnt vmcnt(0)
    s_mov_b64 exec, 1
    buffer_store_dwordx2 v[16:17], v18, s[32:35], s58 offen sc1
    s_mov_b64 exec, -1
Lskf_103:
Lnf_100:
    s_branch Lslowb_43
Lslow_78:
    s_bitcmp1_b32 s63, 0
    s_cbranch_scc0 Lnf_104
    s_lshl_b32 s68, s40, 2
    s_add_u32 s68, s68, 3
    s_lshl_b32 s69, s62, 18
    v_and_b32 v4, 31, v2
    v_lshrrev_b32 v5, 5, v2
    v_lshlrev_b32 v5, 2, v5
    v_sub_u32 v4, v4, v5
    s_sub_u32 s52, s68, 8
    s_max_i32 s52, s52, 0
    v_mov_b32 v96, 0xf149f2ca
    v_mov_b32 v99, 0xf149f2ca
    v_mov_b32 v97, 0
    v_mov_b32 v80, 0
    v_mov_b32 v81, 0
    v_mov_b32 v82, 0
    v_mov_b32 v83, 0
    v_mov_b32 v84, 0
    v_mov_b32 v85, 0
    v_mov_b32 v86, 0
    v_mov_b32 v87, 0
    v_mov_b32 v88, 0
    v_mov_b32 v89, 0
    v_mov_b32 v90, 0
    v_mov_b32 v91, 0
    v_mov_b32 v92, 0
    v_mov_b32 v93, 0
    v_mov_b32 v94, 0
    v_mov_b32 v95, 0
    s_movk_i32 s57, 256
    s_mov_b32 s53, s52
Lat_105:
    s_lshl_b32 s54, s53, 12
    s_add_u32 s54, s54, s69
    buffer_load_dwordx4 v[32:35], v3, s[32:35], s54 offen sc1
    buffer_load_dwordx4 v[36:39], v3, s[32:35], s54 offen offset:1024 sc1
    s_sub_u32 s55, s68, s53
    s_lshl_b32 s55, s55, 5
    v_add_u32 v100, s55, v4
    s_waitcnt vmcnt(0)
    v_mfma_f32_32x32x16_bf16 v[48:63], v[32:35], v[168:171], 0
    v_mfma_f32_32x32x16_bf16 v[48:63], v[36:39], v[172:175], v[48:63]
    s_nop 15
    v_subrev_u32 v98, 0, v100
    v_cmp_gt_u32 vcc, s57, v98
    s_nop 1
    v_cndmask_b32 v48, v99, v48, vcc
    v_max_f32 v96, v96, v48
    v_subrev_u32 v98, 1, v100
    v_cmp_gt_u32 vcc, s57, v98
    s_nop 1
    v_cndmask_b32 v49, v99, v49, vcc
    v_max_f32 v96, v96, v49
    v_subrev_u32 v98, 2, v100
    v_cmp_gt_u32 vcc, s57, v98
    s_nop 1
    v_cndmask_b32 v50, v99, v50, vcc
    v_max_f32 v96, v96, v50
    v_subrev_u32 v98, 3, v100
    v_cmp_gt_u32 vcc, s57, v98
    s_nop 1
    v_cndmask_b32 v51, v99, v51, vcc
    v_max_f32 v96, v96, v51
    v_subrev_u32 v98, 8, v100
    v_cmp_gt_u32 vcc, s57, v98
    s_nop 1
    v_cndmask_b32 v52, v99, v52, vcc
    v_max_f32 v96, v96, v52
    v_subrev_u32 v98, 9, v100
    v_cmp_gt_u32 vcc, s57, v98
    s_nop 1
    v_cndmask_b32 v53, v99, v53, vcc
    v_max_f32 v96, v96, v53
    v_subrev_u32 v98, 10, v100
    v_cmp_gt_u32 vcc, s57, v98
    s_nop 1
    v_cndmask_b32 v54, v99, v54, vcc
    v_max_f32 v96, v96, v54
    v_subrev_u32 v98, 11, v100
    v_cmp_gt_u32 vcc, s57, v98
    s_nop 1
    v_cndmask_b32 v55, v99, v55, vcc
    v_max_f32 v96, v96, v55
    v_subrev_u32 v98, 16, v100
    v_cmp_gt_u32 vcc, s57, v98
    s_nop 1
    v_cndmask_b32 v56, v99, v56, vcc
    v_max_f32 v96, v96, v56
    v_subrev_u32 v98, 17, v100
    v_cmp_gt_u32 vcc, s57, v98
    s_nop 1
    v_cndmask_b32 v57, v99, v57, vcc
    v_max_f32 v96, v96, v57
    v_subrev_u32 v98, 18, v100
    v_cmp_gt_u32 vcc, s57, v98
    s_nop 1
    v_cndmask_b32 v58, v99, v58, vcc
    v_max_f32 v96, v96, v58
    v_subrev_u32 v98, 19, v100
    v_cmp_gt_u32 vcc, s57, v98
    s_nop 1
    v_cndmask_b32 v59, v99, v59, vcc
    v_max_f32 v96, v96, v59
    v_subrev_u32 v98, 24, v100
    v_cmp_gt_u32 vcc, s57, v98
    s_nop 1
    v_cndmask_b32 v60, v99, v60, vcc
    v_max_f32 v96, v96, v60
    v_subrev_u32 v98, 25, v100
    v_cmp_gt_u32 vcc, s57, v98
    s_nop 1
    v_cndmask_b32 v61, v99, v61, vcc
    v_max_f32 v96, v96, v61
    v_subrev_u32 v98, 26, v100
    v_cmp_gt_u32 vcc, s57, v98
    s_nop 1
    v_cndmask_b32 v62, v99, v62, vcc
    v_max_f32 v96, v96, v62
    v_subrev_u32 v98, 27, v100
    v_cmp_gt_u32 vcc, s57, v98
    s_nop 1
    v_cndmask_b32 v63, v99, v63, vcc
    v_max_f32 v96, v96, v63
    s_add_u32 s53, s53, 1
    s_cmp_le_u32 s53, s68
    s_cbranch_scc1 Lat_105
    v_mov_b32 v98, v96
    s_nop 1
    v_permlane32_swap_b32 v98, v96
    s_nop 1
    v_max_f32 v96, v96, v98
    s_mov_b32 s53, s52
Lat_106:
    s_lshl_b32 s54, s53, 12
    s_add_u32 s54, s54, s69
    buffer_load_dwordx4 v[32:35], v3, s[32:35], s54 offen sc1
    buffer_load_dwordx4 v[36:39], v3, s[32:35], s54 offen offset:1024 sc1
    buffer_load_dwordx4 v[40:43], v3, s[32:35], s54 offen offset:2048 sc1
    buffer_load_dwordx4 v[44:47], v3, s[32:35], s54 offen offset:3072 sc1
    s_sub_u32 s55, s68, s53
    s_lshl_b32 s55, s55, 5
    v_add_u32 v100, s55, v4
    s_waitcnt vmcnt(0)
    v_mfma_f32_32x32x16_bf16 v[48:63], v[32:35], v[168:171], 0
    v_mfma_f32_32x32x16_bf16 v[48:63], v[36:39], v[172:175], v[48:63]
    s_nop 15
    v_subrev_u32 v98, 0, v100
    v_cmp_gt_u32 vcc, s57, v98
    s_nop 1
    v_cndmask_b32 v48, v99, v48, vcc
    v_sub_f32 v48, v48, v96
    v_exp_f32 v48, v48
    s_nop 0
    v_add_f32 v97, v97, v48
    v_subrev_u32 v98, 1, v100
    v_cmp_gt_u32 vcc, s57, v98
    s_nop 1
    v_cndmask_b32 v49, v99, v49, vcc
    v_sub_f32 v49, v49, v96
    v_exp_f32 v49, v49
    s_nop 0
    v_add_f32 v97, v97, v49
    v_subrev_u32 v98, 2, v100
    v_cmp_gt_u32 vcc, s57, v98
    s_nop 1
    v_cndmask_b32 v50, v99, v50, vcc
    v_sub_f32 v50, v50, v96
    v_exp_f32 v50, v50
    s_nop 0
    v_add_f32 v97, v97, v50
    v_subrev_u32 v98, 3, v100
    v_cmp_gt_u32 vcc, s57, v98
    s_nop 1
    v_cndmask_b32 v51, v99, v51, vcc
    v_sub_f32 v51, v51, v96
    v_exp_f32 v51, v51
    s_nop 0
    v_add_f32 v97, v97, v51
    v_subrev_u32 v98, 8, v100
    v_cmp_gt_u32 vcc, s57, v98
    s_nop 1
    v_cndmask_b32 v52, v99, v52, vcc
    v_sub_f32 v52, v52, v96
    v_exp_f32 v52, v52
    s_nop 0
    v_add_f32 v97, v97, v52
    v_subrev_u32 v98, 9, v100
    v_cmp_gt_u32 vcc, s57, v98
    s_nop 1
    v_cndmask_b32 v53, v99, v53, vcc
    v_sub_f32 v53, v53, v96
    v_exp_f32 v53, v53
    s_nop 0
    v_add_f32 v97, v97, v53
    v_subrev_u32 v98, 10, v100
    v_cmp_gt_u32 vcc, s57, v98
    s_nop 1
    v_cndmask_b32 v54, v99, v54, vcc
    v_sub_f32 v54, v54, v96
    v_exp_f32 v54, v54
    s_nop 0
    v_add_f32 v97, v97, v54
    v_subrev_u32 v98, 11, v100
    v_cmp_gt_u32 vcc, s57, v98
    s_nop 1
    v_cndmask_b32 v55, v99, v55, vcc
    v_sub_f32 v55, v55, v96
    v_exp_f32 v55, v55
    s_nop 0
    v_add_f32 v97, v97, v55
    v_subrev_u32 v98, 16, v100
    v_cmp_gt_u32 vcc, s57, v98
    s_nop 1
    v_cndmask_b32 v56, v99, v56, vcc
    v_sub_f32 v56, v56, v96
    v_exp_f32 v56, v56
    s_nop 0
    v_add_f32 v97, v97, v56
    v_subrev_u32 v98, 17, v100
    v_cmp_gt_u32 vcc, s57, v98
    s_nop 1
    v_cndmask_b32 v57, v99, v57, vcc
    v_sub_f32 v57, v57, v96
    v_exp_f32 v57, v57
    s_nop 0
    v_add_f32 v97, v97, v57
    v_subrev_u32 v98, 18, v100
    v_cmp_gt_u32 vcc, s57, v98
    s_nop 1
    v_cndmask_b32 v58, v99, v58, vcc
    v_sub_f32 v58, v58, v96
    v_exp_f32 v58, v58
    s_nop 0
    v_add_f32 v97, v97, v58
    v_subrev_u32 v98, 19, v100
    v_cmp_gt_u32 vcc, s57, v98
    s_nop 1
    v_cndmask_b32 v59, v99, v59, vcc
    v_sub_f32 v59, v59, v96
    v_exp_f32 v59, v59
    s_nop 0
    v_add_f32 v97, v97, v59
    v_subrev_u32 v98, 24, v100
    v_cmp_gt_u32 vcc, s57, v98
    s_nop 1
    v_cndmask_b32 v60, v99, v60, vcc
    v_sub_f32 v60, v60, v96
    v_exp_f32 v60, v60
    s_nop 0
    v_add_f32 v97, v97, v60
    v_subrev_u32 v98, 25, v100
    v_cmp_gt_u32 vcc, s57, v98
    s_nop 1
    v_cndmask_b32 v61, v99, v61, vcc
    v_sub_f32 v61, v61, v96
    v_exp_f32 v61, v61
    s_nop 0
    v_add_f32 v97, v97, v61
    v_subrev_u32 v98, 26, v100
    v_cmp_gt_u32 vcc, s57, v98
    s_nop 1
    v_cndmask_b32 v62, v99, v62, vcc
    v_sub_f32 v62, v62, v96
    v_exp_f32 v62, v62
    s_nop 0
    v_add_f32 v97, v97, v62
    v_subrev_u32 v98, 27, v100
    v_cmp_gt_u32 vcc, s57, v98
    s_nop 1
    v_cndmask_b32 v63, v99, v63, vcc
    v_sub_f32 v63, v63, v96
    v_exp_f32 v63, v63
    s_nop 0
    v_add_f32 v97, v97, v63
    v_cvt_pk_bf16_f32 v64, v48, v49
    v_cvt_pk_bf16_f32 v65, v50, v51
    v_cvt_pk_bf16_f32 v66, v52, v53
    v_cvt_pk_bf16_f32 v67, v54, v55
    v_cvt_pk_bf16_f32 v68, v56, v57
    v_cvt_pk_bf16_f32 v69, v58, v59
    v_cvt_pk_bf16_f32 v70, v60, v61
    v_cvt_pk_bf16_f32 v71, v62, v63
    s_nop 1
    v_mfma_f32_32x32x16_bf16 v[80:95], v[40:43], v[64:67], v[80:95]
    v_mfma_f32_32x32x16_bf16 v[80:95], v[44:47], v[68:71], v[80:95]
    s_add_u32 s53, s53, 1
    s_cmp_le_u32 s53, s68
    s_cbranch_scc1 Lat_106
    v_mov_b32 v98, v97
    s_nop 1
    v_permlane32_swap_b32 v98, v97
    s_nop 1
    v_add_f32 v97, v97, v98
    v_rcp_f32 v97, v97
    s_nop 15
    v_mul_f32 v80, v80, v97
    v_mul_f32 v81, v81, v97
    v_mul_f32 v82, v82, v97
    v_mul_f32 v83, v83, v97
    v_mul_f32 v84, v84, v97
    v_mul_f32 v85, v85, v97
    v_mul_f32 v86, v86, v97
    v_mul_f32 v87, v87, v97
    v_mul_f32 v88, v88, v97
    v_mul_f32 v89, v89, v97
    v_mul_f32 v90, v90, v97
    v_mul_f32 v91, v91, v97
    v_mul_f32 v92, v92, v97
    v_mul_f32 v93, v93, v97
    v_mul_f32 v94, v94, v97
    v_mul_f32 v95, v95, v97
    v_cvt_pk_bf16_f32 v24, v80, v81
    v_cvt_pk_bf16_f32 v25, v82, v83
    v_cvt_pk_bf16_f32 v26, v84, v85
    v_cvt_pk_bf16_f32 v27, v86, v87
    v_cvt_pk_bf16_f32 v28, v88, v89
    v_cvt_pk_bf16_f32 v29, v90, v91
    v_cvt_pk_bf16_f32 v30, v92, v93
    v_cvt_pk_bf16_f32 v31, v94, v95
    v_and_b32 v102, 15, v2
    v_lshlrev_b32 v102, 4, v102
    v_bfe_u32 v103, v2, 4, 1
    v_lshl_add_u32 v102, v103, 10, v102
    v_lshrrev_b32 v103, 5, v2
    v_lshl_add_u32 v102, v103, 8, v102
    s_add_u32 s58, s66, 196608
    buffer_store_dwordx4 v[24:27], v102, s[32:35], s58 offen sc1
    buffer_store_dwordx4 v[28:31], v102, s[32:35], s58 offen offset:512 sc1
    v_mov_b32 v16, s60
    v_mov_b32 v17, s61
    v_mov_b32 v18, 0
    s_add_u32 s58, s67, 3072
    s_waitcnt vmcnt(0)
    s_mov_b64 exec, 1
    buffer_store_dwordx2 v[16:17], v18, s[32:35], s58 offen sc1
    s_mov_b64 exec, -1
Lskf_107:
Lnf_104:
    s_bitcmp1_b32 s63, 1
    s_cbranch_scc0 Lnf_108
    s_lshl_b32 s68, s40, 2
    s_add_u32 s68, s68, 0
    s_lshl_b32 s69, s62, 18
    v_and_b32 v4, 31, v2
    v_lshrrev_b32 v5, 5, v2
    v_lshlrev_b32 v5, 2, v5
    v_sub_u32 v4, v4, v5
    s_sub_u32 s52, s68, 8
    s_max_i32 s52, s52, 0
    v_mov_b32 v96, 0xf149f2ca
    v_mov_b32 v99, 0xf149f2ca
    v_mov_b32 v97, 0
    v_mov_b32 v80, 0
    v_mov_b32 v81, 0
    v_mov_b32 v82, 0
    v_mov_b32 v83, 0
    v_mov_b32 v84, 0
    v_mov_b32 v85, 0
    v_mov_b32 v86, 0
    v_mov_b32 v87, 0
    v_mov_b32 v88, 0
    v_mov_b32 v89, 0
    v_mov_b32 v90, 0
    v_mov_b32 v91, 0
    v_mov_b32 v92, 0
    v_mov_b32 v93, 0
    v_mov_b32 v94, 0
    v_mov_b32 v95, 0
    s_movk_i32 s57, 256
    s_mov_b32 s53, s52
Lat_109:
    s_lshl_b32 s54, s53, 12
    s_add_u32 s54, s54, s69
    buffer_load_dwordx4 v[32:35], v3, s[32:35], s54 offen sc1
    buffer_load_dwordx4 v[36:39], v3, s[32:35], s54 offen offset:1024 sc1
    s_sub_u32 s55, s68, s53
    s_lshl_b32 s55, s55, 5
    v_add_u32 v100, s55, v4
    s_waitcnt vmcnt(0)
    v_mfma_f32_32x32x16_bf16 v[48:63], v[32:35], v[144:147], 0
    v_mfma_f32_32x32x16_bf16 v[48:63], v[36:39], v[148:151], v[48:63]
    s_nop 15
    v_subrev_u32 v98, 0, v100
    v_cmp_gt_u32 vcc, s57, v98
    s_nop 1
    v_cndmask_b32 v48, v99, v48, vcc
    v_max_f32 v96, v96, v48
    v_subrev_u32 v98, 1, v100
    v_cmp_gt_u32 vcc, s57, v98
    s_nop 1
    v_cndmask_b32 v49, v99, v49, vcc
    v_max_f32 v96, v96, v49
    v_subrev_u32 v98, 2, v100
    v_cmp_gt_u32 vcc, s57, v98
    s_nop 1
    v_cndmask_b32 v50, v99, v50, vcc
    v_max_f32 v96, v96, v50
    v_subrev_u32 v98, 3, v100
    v_cmp_gt_u32 vcc, s57, v98
    s_nop 1
    v_cndmask_b32 v51, v99, v51, vcc
    v_max_f32 v96, v96, v51
    v_subrev_u32 v98, 8, v100
    v_cmp_gt_u32 vcc, s57, v98
    s_nop 1
    v_cndmask_b32 v52, v99, v52, vcc
    v_max_f32 v96, v96, v52
    v_subrev_u32 v98, 9, v100
    v_cmp_gt_u32 vcc, s57, v98
    s_nop 1
    v_cndmask_b32 v53, v99, v53, vcc
    v_max_f32 v96, v96, v53
    v_subrev_u32 v98, 10, v100
    v_cmp_gt_u32 vcc, s57, v98
    s_nop 1
    v_cndmask_b32 v54, v99, v54, vcc
    v_max_f32 v96, v96, v54
    v_subrev_u32 v98, 11, v100
    v_cmp_gt_u32 vcc, s57, v98
    s_nop 1
    v_cndmask_b32 v55, v99, v55, vcc
    v_max_f32 v96, v96, v55
    v_subrev_u32 v98, 16, v100
    v_cmp_gt_u32 vcc, s57, v98
    s_nop 1
    v_cndmask_b32 v56, v99, v56, vcc
    v_max_f32 v96, v96, v56
    v_subrev_u32 v98, 17, v100
    v_cmp_gt_u32 vcc, s57, v98
    s_nop 1
    v_cndmask_b32 v57, v99, v57, vcc
    v_max_f32 v96, v96, v57
    v_subrev_u32 v98, 18, v100
    v_cmp_gt_u32 vcc, s57, v98
    s_nop 1
    v_cndmask_b32 v58, v99, v58, vcc
    v_max_f32 v96, v96, v58
    v_subrev_u32 v98, 19, v100
    v_cmp_gt_u32 vcc, s57, v98
    s_nop 1
    v_cndmask_b32 v59, v99, v59, vcc
    v_max_f32 v96, v96, v59
    v_subrev_u32 v98, 24, v100
    v_cmp_gt_u32 vcc, s57, v98
    s_nop 1
    v_cndmask_b32 v60, v99, v60, vcc
    v_max_f32 v96, v96, v60
    v_subrev_u32 v98, 25, v100
    v_cmp_gt_u32 vcc, s57, v98
    s_nop 1
    v_cndmask_b32 v61, v99, v61, vcc
    v_max_f32 v96, v96, v61
    v_subrev_u32 v98, 26, v100
    v_cmp_gt_u32 vcc, s57, v98
    s_nop 1
    v_cndmask_b32 v62, v99, v62, vcc
    v_max_f32 v96, v96, v62
    v_subrev_u32 v98, 27, v100
    v_cmp_gt_u32 vcc, s57, v98
    s_nop 1
    v_cndmask_b32 v63, v99, v63, vcc
    v_max_f32 v96, v96, v63
    s_add_u32 s53, s53, 1
    s_cmp_le_u32 s53, s68
    s_cbranch_scc1 Lat_109
    v_mov_b32 v98, v96
    s_nop 1
    v_permlane32_swap_b32 v98, v96
    s_nop 1
    v_max_f32 v96, v96, v98
    s_mov_b32 s53, s52
Lat_110:
    s_lshl_b32 s54, s53, 12
    s_add_u32 s54, s54, s69
    buffer_load_dwordx4 v[32:35], v3, s[32:35], s54 offen sc1
    buffer_load_dwordx4 v[36:39], v3, s[32:35], s54 offen offset:1024 sc1
    buffer_load_dwordx4 v[40:43], v3, s[32:35], s54 offen offset:2048 sc1
    buffer_load_dwordx4 v[44:47], v3, s[32:35], s54 offen offset:3072 sc1
    s_sub_u32 s55, s68, s53
    s_lshl_b32 s55, s55, 5
    v_add_u32 v100, s55, v4
    s_waitcnt vmcnt(0)
    v_mfma_f32_32x32x16_bf16 v[48:63], v[32:35], v[144:147], 0
    v_mfma_f32_32x32x16_bf16 v[48:63], v[36:39], v[148:151], v[48:63]
    s_nop 15
    v_subrev_u32 v98, 0, v100
    v_cmp_gt_u32 vcc, s57, v98
    s_nop 1
    v_cndmask_b32 v48, v99, v48, vcc
    v_sub_f32 v48, v48, v96
    v_exp_f32 v48, v48
    s_nop 0
    v_add_f32 v97, v97, v48
    v_subrev_u32 v98, 1, v100
    v_cmp_gt_u32 vcc, s57, v98
    s_nop 1
    v_cndmask_b32 v49, v99, v49, vcc
    v_sub_f32 v49, v49, v96
    v_exp_f32 v49, v49
    s_nop 0
    v_add_f32 v97, v97, v49
    v_subrev_u32 v98, 2, v100
    v_cmp_gt_u32 vcc, s57, v98
    s_nop 1
    v_cndmask_b32 v50, v99, v50, vcc
    v_sub_f32 v50, v50, v96
    v_exp_f32 v50, v50
    s_nop 0
    v_add_f32 v97, v97, v50
    v_subrev_u32 v98, 3, v100
    v_cmp_gt_u32 vcc, s57, v98
    s_nop 1
    v_cndmask_b32 v51, v99, v51, vcc
    v_sub_f32 v51, v51, v96
    v_exp_f32 v51, v51
    s_nop 0
    v_add_f32 v97, v97, v51
    v_subrev_u32 v98, 8, v100
    v_cmp_gt_u32 vcc, s57, v98
    s_nop 1
    v_cndmask_b32 v52, v99, v52, vcc
    v_sub_f32 v52, v52, v96
    v_exp_f32 v52, v52
    s_nop 0
    v_add_f32 v97, v97, v52
    v_subrev_u32 v98, 9, v100
    v_cmp_gt_u32 vcc, s57, v98
    s_nop 1
    v_cndmask_b32 v53, v99, v53, vcc
    v_sub_f32 v53, v53, v96
    v_exp_f32 v53, v53
    s_nop 0
    v_add_f32 v97, v97, v53
    v_subrev_u32 v98, 10, v100
    v_cmp_gt_u32 vcc, s57, v98
    s_nop 1
    v_cndmask_b32 v54, v99, v54, vcc
    v_sub_f32 v54, v54, v96
    v_exp_f32 v54, v54
    s_nop 0
    v_add_f32 v97, v97, v54
    v_subrev_u32 v98, 11, v100
    v_cmp_gt_u32 vcc, s57, v98
    s_nop 1
    v_cndmask_b32 v55, v99, v55, vcc
    v_sub_f32 v55, v55, v96
    v_exp_f32 v55, v55
    s_nop 0
    v_add_f32 v97, v97, v55
    v_subrev_u32 v98, 16, v100
    v_cmp_gt_u32 vcc, s57, v98
    s_nop 1
    v_cndmask_b32 v56, v99, v56, vcc
    v_sub_f32 v56, v56, v96
    v_exp_f32 v56, v56
    s_nop 0
    v_add_f32 v97, v97, v56
    v_subrev_u32 v98, 17, v100
    v_cmp_gt_u32 vcc, s57, v98
    s_nop 1
    v_cndmask_b32 v57, v99, v57, vcc
    v_sub_f32 v57, v57, v96
    v_exp_f32 v57, v57
    s_nop 0
    v_add_f32 v97, v97, v57
    v_subrev_u32 v98, 18, v100
    v_cmp_gt_u32 vcc, s57, v98
    s_nop 1
    v_cndmask_b32 v58, v99, v58, vcc
    v_sub_f32 v58, v58, v96
    v_exp_f32 v58, v58
    s_nop 0
    v_add_f32 v97, v97, v58
    v_subrev_u32 v98, 19, v100
    v_cmp_gt_u32 vcc, s57, v98
    s_nop 1
    v_cndmask_b32 v59, v99, v59, vcc
    v_sub_f32 v59, v59, v96
    v_exp_f32 v59, v59
    s_nop 0
    v_add_f32 v97, v97, v59
    v_subrev_u32 v98, 24, v100
    v_cmp_gt_u32 vcc, s57, v98
    s_nop 1
    v_cndmask_b32 v60, v99, v60, vcc
    v_sub_f32 v60, v60, v96
    v_exp_f32 v60, v60
    s_nop 0
    v_add_f32 v97, v97, v60
    v_subrev_u32 v98, 25, v100
    v_cmp_gt_u32 vcc, s57, v98
    s_nop 1
    v_cndmask_b32 v61, v99, v61, vcc
    v_sub_f32 v61, v61, v96
    v_exp_f32 v61, v61
    s_nop 0
    v_add_f32 v97, v97, v61
    v_subrev_u32 v98, 26, v100
    v_cmp_gt_u32 vcc, s57, v98
    s_nop 1
    v_cndmask_b32 v62, v99, v62, vcc
    v_sub_f32 v62, v62, v96
    v_exp_f32 v62, v62
    s_nop 0
    v_add_f32 v97, v97, v62
    v_subrev_u32 v98, 27, v100
    v_cmp_gt_u32 vcc, s57, v98
    s_nop 1
    v_cndmask_b32 v63, v99, v63, vcc
    v_sub_f32 v63, v63, v96
    v_exp_f32 v63, v63
    s_nop 0
    v_add_f32 v97, v97, v63
    v_cvt_pk_bf16_f32 v64, v48, v49
    v_cvt_pk_bf16_f32 v65, v50, v51
    v_cvt_pk_bf16_f32 v66, v52, v53
    v_cvt_pk_bf16_f32 v67, v54, v55
    v_cvt_pk_bf16_f32 v68, v56, v57
    v_cvt_pk_bf16_f32 v69, v58, v59
    v_cvt_pk_bf16_f32 v70, v60, v61
    v_cvt_pk_bf16_f32 v71, v62, v63
    s_nop 1
    v_mfma_f32_32x32x16_bf16 v[80:95], v[40:43], v[64:67], v[80:95]
    v_mfma_f32_32x32x16_bf16 v[80:95], v[44:47], v[68:71], v[80:95]
    s_add_u32 s53, s53, 1
    s_cmp_le_u32 s53, s68
    s_cbranch_scc1 Lat_110
    v_mov_b32 v98, v97
    s_nop 1
    v_permlane32_swap_b32 v98, v97
    s_nop 1
    v_add_f32 v97, v97, v98
    v_rcp_f32 v97, v97
    s_nop 15
    v_mul_f32 v80, v80, v97
    v_mul_f32 v81, v81, v97
    v_mul_f32 v82, v82, v97
    v_mul_f32 v83, v83, v97
    v_mul_f32 v84, v84, v97
    v_mul_f32 v85, v85, v97
    v_mul_f32 v86, v86, v97
    v_mul_f32 v87, v87, v97
    v_mul_f32 v88, v88, v97
    v_mul_f32 v89, v89, v97
    v_mul_f32 v90, v90, v97
    v_mul_f32 v91, v91, v97
    v_mul_f32 v92, v92, v97
    v_mul_f32 v93, v93, v97
    v_mul_f32 v94, v94, v97
    v_mul_f32 v95, v95, v97
    v_cvt_pk_bf16_f32 v24, v80, v81
    v_cvt_pk_bf16_f32 v25, v82, v83
    v_cvt_pk_bf16_f32 v26, v84, v85
    v_cvt_pk_bf16_f32 v27, v86, v87
    v_cvt_pk_bf16_f32 v28, v88, v89
    v_cvt_pk_bf16_f32 v29, v90, v91
    v_cvt_pk_bf16_f32 v30, v92, v93
    v_cvt_pk_bf16_f32 v31, v94, v95
    v_and_b32 v102, 15, v2
    v_lshlrev_b32 v102, 4, v102
    v_bfe_u32 v103, v2, 4, 1
    v_lshl_add_u32 v102, v103, 10, v102
    v_lshrrev_b32 v103, 5, v2
    v_lshl_add_u32 v102, v103, 8, v102
    s_add_u32 s58, s66, 0
    buffer_store_dwordx4 v[24:27], v102, s[32:35], s58 offen sc1
    buffer_store_dwordx4 v[28:31], v102, s[32:35], s58 offen offset:512 sc1
    v_mov_b32 v16, s60
    v_mov_b32 v17, s61
    v_mov_b32 v18, 0
    s_add_u32 s58, s67, 0
    s_waitcnt vmcnt(0)
    s_mov_b64 exec, 1
    buffer_store_dwordx2 v[16:17], v18, s[32:35], s58 offen sc1
    s_mov_b64 exec, -1
Lskf_111:
Lnf_108:
    s_branch Lslowb_79
L_ld_tail:
    s_barrier
    s_mov_b32 s24, s8
    s_mov_b32 s25, s9
    s_mov_b32 s26, 0x200000
    s_mov_b32 s27, 0x20000
    s_mov_b32 s28, s10
    s_mov_b32 s29, s11
    s_mov_b32 s30, 0x400000
    s_mov_b32 s31, 0x20000
    s_mov_b32 s32, s14
    s_mov_b32 s33, s15
    s_mov_b32 s34, 0x10000000
    s_mov_b32 s35, 0x20000
    v_lshrrev_b32 v3, 3, v2
    v_and_b32 v4, 7, v2
    v_and_b32 v5, 6, v3
    v_xor_b32 v4, v4, v5
    v_lshlrev_b32 v3, 11, v3
    v_lshl_add_u32 v3, v4, 4, v3
    s_lshl_b32 s44, s40, 7
    v_add_u32 v12, s44, v3
    v_mov_b32 v1, 24576
    ds_read_b64 v[24:25], v1
    s_waitcnt lgkmcnt(0)
    v_readfirstlane_b32 s60, v24
    v_readfirstlane_b32 s61, v25
    s_barrier
L_ht:
    s_sub_u32 s43, s42, 4
    s_and_b32 s44, s43, 1
    s_lshr_b32 s45, s43, 1
    v_lshlrev_b32 v3, 4, v2
    v_and_b32 v14, 3, v2
    v_lshlrev_b32 v14, 2, v14
    s_cmp_lg_u32 s42, 7
    s_cbranch_scc1 L_nkp
    s_lshl_b32 s46, s41, 6
    s_lshl_b32 s47, s40, 1
    s_add_u32 s46, s46, s47
    s_lshl_b32 s46, s46, 7
    s_add_u32 s46, s46, 12582400
    v_bfe_u32 v4, v2, 2, 1
    v_xor_b32 v4, 1, v4
    s_cmp_ge_u32 s40, 2
    s_cselect_b32 s47, 0, 1
    v_or_b32 v4, s47, v4
    v_lshlrev_b32 v4, 1, v4
    v_and_b32 v5, 1, v2
    v_add_u32 v4, v4, v5
    v_bfe_u32 v5, v2, 1, 1
    v_lshl_add_u32 v4, v5, 5, v4
    v_lshlrev_b32 v4, 7, v4
    s_cmp_eq_u32 s40, 0
    s_cbranch_scc1 L_pkg
    s_add_u32 s47, s46, 0x40000
    s_mov_b32 s54, 0
L_pl:
    buffer_load_dwordx2 v[6:7], v4, s[32:35], s47 offen sc1
    s_add_u32 s54, s54, 1
    s_waitcnt vmcnt(0)
    v_cmp_ne_u64 vcc, s[60:61], v[6:7]
    s_cbranch_vccz L_pkg
    s_cmp_lt_u32 s54, 24
    s_cbranch_scc1 L_pl
    s_mov_b32 s54, 0
L_pk:
    buffer_load_dwordx2 v[6:7], v4, s[32:35], s46 offen sc1
    s_add_u32 s54, s54, 1
    s_cmp_gt_u32 s54, 400000
    s_cbranch_scc1 L_pkg
    s_waitcnt vmcnt(0)
    v_cmp_ne_u64 vcc, s[60:61], v[6:7]
    s_cbranch_vccz L_pkg
    s_sleep 2
    s_branch L_pk
L_pkg:
    s_add_u32 s58, s60, 1
    v_mov_b32 v15, s58
    ds_write_b32 v14, v15 offset:17472
L_nkp:
    s_add_u32 s59, s60, 1
Lw_112:
    ds_read_b32 v15, v14 offset:17536
    s_waitcnt lgkmcnt(0)
    v_cmp_ne_u32 vcc, s59, v15
    s_cbranch_vccz Lwd_113
    s_sleep 1
    s_branch Lw_112
Lwd_113:
    s_mul_i32 s51, s43, 22528
    s_mul_i32 s52, s43, 360448
    s_add_u32 m0, s51, 32768
    s_add_u32 s48, s52, 0
    buffer_load_dwordx4 v12, s[24:27], s48 offen lds
    s_add_u32 m0, s51, 33792
    s_add_u32 s48, s52, 16384
    buffer_load_dwordx4 v12, s[24:27], s48 offen lds
    s_add_u32 m0, s51, 34816
    s_add_u32 s48, s52, 32768
    buffer_load_dwordx4 v12, s[24:27], s48 offen lds
    s_add_u32 m0, s51, 35840
    s_add_u32 s48, s52, 49152
    buffer_load_dwordx4 v12, s[24:27], s48 offen lds
    s_add_u32 m0, s51, 36864
    s_add_u32 s48, s52, 65536
    buffer_load_dwordx4 v12, s[24:27], s48 offen lds
    s_add_u32 m0, s51, 37888
    s_add_u32 s48, s52, 81920
    buffer_load_dwordx4 v12, s[24:27], s48 offen lds
    s_add_u32 m0, s51, 38912
    s_add_u32 s48, s52, 98304
    buffer_load_dwordx4 v12, s[24:27], s48 offen lds
    s_add_u32 m0, s51, 39936
    s_add_u32 s48, s52, 114688
    buffer_load_dwordx4 v12, s[24:27], s48 offen lds
    s_add_u32 m0, s51, 40960
    s_add_u32 s48, s52, 131072
    buffer_load_dwordx4 v12, s[24:27], s48 offen lds
    s_add_u32 m0, s51, 41984
    s_add_u32 s48, s52, 147456
    buffer_load_dwordx4 v12, s[24:27], s48 offen lds
    s_add_u32 m0, s51, 43008
    s_add_u32 s48, s52, 163840
    buffer_load_dwordx4 v12, s[24:27], s48 offen lds
    s_add_u32 m0, s51, 44032
    s_add_u32 s48, s52, 180224
    buffer_load_dwordx4 v12, s[24:27], s48 offen lds
    s_add_u32 m0, s51, 45056
    s_add_u32 s48, s52, 196608
    buffer_load_dwordx4 v12, s[24:27], s48 offen lds
    s_add_u32 m0, s51, 46080
    s_add_u32 s48, s52, 212992
    buffer_load_dwordx4 v12, s[24:27], s48 offen lds
    s_add_u32 m0, s51, 47104
    s_add_u32 s48, s52, 229376
    buffer_load_dwordx4 v12, s[24:27], s48 offen lds
    s_add_u32 m0, s51, 48128
    s_add_u32 s48, s52, 245760
    buffer_load_dwordx4 v12, s[24:27], s48 offen lds
    s_add_u32 m0, s51, 49152
    s_add_u32 s48, s52, 262144
    buffer_load_dwordx4 v12, s[24:27], s48 offen lds
    s_add_u32 m0, s51, 50176
    s_add_u32 s48, s52, 278528
    buffer_load_dwordx4 v12, s[24:27], s48 offen lds
    s_add_u32 m0, s51, 51200
    s_add_u32 s48, s52, 294912
    buffer_load_dwordx4 v12, s[24:27], s48 offen lds
    s_add_u32 m0, s51, 52224
    s_add_u32 s48, s52, 311296
    buffer_load_dwordx4 v12, s[24:27], s48 offen lds
    s_add_u32 m0, s51, 53248
    s_add_u32 s48, s52, 327680
    buffer_load_dwordx4 v12, s[24:27], s48 offen lds
    s_add_u32 m0, s51, 54272
    s_add_u32 s48, s52, 344064
    buffer_load_dwordx4 v12, s[24:27], s48 offen lds
    s_mul_i32 s51, s43, 10240
    s_mul_i32 s52, s43, 163840
    s_add_u32 m0, s51, 122880
    s_add_u32 s48, s52, 1441792
    buffer_load_dwordx4 v12, s[24:27], s48 offen lds
    s_add_u32 m0, s51, 123904
    s_add_u32 s48, s52, 1458176
    buffer_load_dwordx4 v12, s[24:27], s48 offen lds
    s_add_u32 m0, s51, 124928
    s_add_u32 s48, s52, 1474560
    buffer_load_dwordx4 v12, s[24:27], s48 offen lds
    s_add_u32 m0, s51, 125952
    s_add_u32 s48, s52, 1490944
    buffer_load_dwordx4 v12, s[24:27], s48 offen lds
    s_add_u32 m0, s51, 126976
    s_add_u32 s48, s52, 1507328
    buffer_load_dwordx4 v12, s[24:27], s48 offen lds
    s_add_u32 m0, s51, 128000
    s_add_u32 s48, s52, 1523712
    buffer_load_dwordx4 v12, s[24:27], s48 offen lds
    s_add_u32 m0, s51, 129024
    s_add_u32 s48, s52, 1540096
    buffer_load_dwordx4 v12, s[24:27], s48 offen lds
    s_add_u32 m0, s51, 130048
    s_add_u32 s48, s52, 1556480
    buffer_load_dwordx4 v12, s[24:27], s48 offen lds
    s_add_u32 m0, s51, 131072
    s_add_u32 s48, s52, 1572864
    buffer_load_dwordx4 v12, s[24:27], s48 offen lds
    s_add_u32 m0, s51, 132096
    s_add_u32 s48, s52, 1589248
    buffer_load_dwordx4 v12, s[24:27], s48 offen lds
    s_lshl_b32 s58, s43, 2
    v_mov_b32 v16, s58
    s_waitcnt vmcnt(0)
    s_add_u32 s58, s60, 1
    v_mov_b32 v15, s58
    ds_write_b32 v16, v15 offset:17488
    s_lshl_b32 s58, s44, 2
    v_mov_b32 v0, s58
    s_cmp_lg_u32 s42, 7
    s_cbranch_scc1 L_np1
    s_add_u32 s59, s60, 1
Lw_114:
    ds_read_b32 v15, v14 offset:17600
    s_waitcnt lgkmcnt(0)
    v_cmp_ne_u32 vcc, s59, v15
    s_cbranch_vccz Lwd_115
    s_sleep 1
    s_branch Lw_114
Lwd_115:
    v_lshlrev_b32 v4, 5, v2
    s_lshl_b32 s50, s41, 12
    s_add_u32 s50, s50, 13633536
    s_mov_b32 s54, 0
L_po1:
    buffer_load_dwordx2 v[6:7], v4, s[32:35], s50 offen sc1
    s_add_u32 s54, s54, 1
    s_cmp_gt_u32 s54, 400000
    s_cbranch_scc1 L_po1g
    s_waitcnt vmcnt(0)
    v_cmp_ne_u64 vcc, s[60:61], v[6:7]
    s_cbranch_vccz L_po1g
    s_sleep 2
    s_branch L_po1
L_po1g:
    v_mov_b32 v14, 0
    s_add_u32 s58, s60, 1
    v_mov_b32 v15, s58
    ds_write_b32 v14, v15 offset:17552
L_np1:
    s_lshl_b32 s48, s41, 2
    s_add_u32 s48, s48, s44
    s_add_u32 s48, s48, 2
    s_lshl_b32 s49, s48, 5
    s_lshl_b32 s50, s45, 4
    s_add_u32 s49, s49, s50
    s_lshl_b32 s49, s49, 11
    s_add_u32 s49, s49, 8388608
    v_lshrrev_b32 v5, 4, v2
    v_bfe_u32 v6, v2, 2, 2
    v_lshrrev_b32 v7, 1, v5
    v_lshlrev_b32 v7, 4, v7
    v_and_b32 v8, 1, v5
    v_lshl_add_u32 v7, v8, 2, v7
    v_add_u32 v7, v7, v6
    v_bfe_u32 v8, v7, 1, 2
    v_lshlrev_b32 v7, 7, v7
    v_lshl_add_u32 v7, v8, 5, v7
    v_and_b32 v6, 3, v2
    v_lshl_add_u32 v7, v6, 3, v7
    s_lshl_b32 s51, s45, 16
    s_add_u32 s51, s51, 32768
    v_add_u32 v10, s51, v7
    v_xor_b32 v11, 32, v10
    v_xor_b32 v12, 64, v10
    v_xor_b32 v13, 96, v10
    s_lshl_b32 s52, s48, 5
    s_lshl_b32 s53, s45, 4
    s_add_u32 s52, s52, s53
    v_and_b32 v5, 15, v2
    v_add_u32 v5, s52, v5
    v_lshlrev_b32 v5, 11, v5
    v_bfe_u32 v6, v2, 4, 1
    v_lshl_add_u32 v5, v6, 5, v5
    v_lshrrev_b32 v6, 5, v2
    v_lshl_add_u32 v5, v6, 4, v5
    s_lshl_b32 s50, s40, 7
    v_add_u32 v5, s50, v5
    s_lshl_b32 s58, s44, 13
    v_add_u32 v4, s58, v3
    v_and_b32 v14, 3, v2
    v_lshlrev_b32 v14, 2, v14
    s_add_u32 s59, s60, 1
Lw_116:
    ds_read_b32 v15, v14 offset:17488
    s_waitcnt lgkmcnt(0)
    v_cmp_ne_u32 vcc, s59, v15
    s_cbranch_vccz Lwd_117
    s_sleep 1
    s_branch Lw_116
Lwd_117:
    ds_read_b64_tr_b16 v[48:49], v10 offset:0
    ds_read_b64_tr_b16 v[50:51], v10 offset:1024
    ds_read_b64_tr_b16 v[52:53], v11 offset:0
    ds_read_b64_tr_b16 v[54:55], v11 offset:1024
    ds_read_b64_tr_b16 v[56:57], v12 offset:0
    ds_read_b64_tr_b16 v[58:59], v12 offset:1024
    ds_read_b64_tr_b16 v[60:61], v13 offset:0
    ds_read_b64_tr_b16 v[62:63], v13 offset:1024
    v_mov_b32 v14, 0
    s_add_u32 s59, s60, 1
Lw_118:
    ds_read_b32 v15, v14 offset:17552
    s_waitcnt lgkmcnt(0)
    v_cmp_ne_u32 vcc, s59, v15
    s_cbranch_vccz Lwd_119
    s_sleep 1
    s_branch Lw_118
Lwd_119:
    s_setprio 2
    buffer_load_dwordx4 v[96:99], v3, s[32:35], s49 offen offset:0 sc1
    buffer_load_dwordx4 v[100:103], v3, s[32:35], s49 offen offset:1024 sc1
    buffer_load_dwordx4 v[104:107], v3, s[32:35], s49 offen offset:2048 sc1
    buffer_load_dwordx4 v[108:111], v3, s[32:35], s49 offen offset:3072 sc1
    s_add_u32 s49, s49, 4096
    buffer_load_dwordx4 v[112:115], v3, s[32:35], s49 offen offset:0 sc1
    buffer_load_dwordx4 v[116:119], v3, s[32:35], s49 offen offset:1024 sc1
    buffer_load_dwordx4 v[120:123], v3, s[32:35], s49 offen offset:2048 sc1
    buffer_load_dwordx4 v[124:127], v3, s[32:35], s49 offen offset:3072 sc1
    s_add_u32 s49, s49, 4096
    s_waitcnt vmcnt(7) lgkmcnt(6)
    v_mfma_f32_16x16x32_bf16 v[16:19], v[48:51], v[96:99], 0
    ds_read_b64_tr_b16 v[64:65], v10 offset:4096
    s_waitcnt vmcnt(6)
    v_mfma_f32_16x16x32_bf16 v[32:35], v[48:51], v[100:103], 0
    ds_read_b64_tr_b16 v[66:67], v10 offset:5120
    s_waitcnt lgkmcnt(6)
    v_mfma_f32_16x16x32_bf16 v[20:23], v[52:55], v[96:99], 0
    ds_read_b64_tr_b16 v[68:69], v11 offset:4096
    buffer_load_dwordx4 v[128:131], v3, s[32:35], s49 offen offset:0 sc1
    v_mfma_f32_16x16x32_bf16 v[36:39], v[52:55], v[100:103], 0
    ds_read_b64_tr_b16 v[70:71], v11 offset:5120
    s_waitcnt lgkmcnt(6)
    v_mfma_f32_16x16x32_bf16 v[24:27], v[56:59], v[96:99], 0
    ds_read_b64_tr_b16 v[72:73], v12 offset:4096
    v_mfma_f32_16x16x32_bf16 v[40:43], v[56:59], v[100:103], 0
    ds_read_b64_tr_b16 v[74:75], v12 offset:5120
    buffer_load_dwordx4 v[132:135], v3, s[32:35], s49 offen offset:1024 sc1
    s_waitcnt lgkmcnt(6)
    v_mfma_f32_16x16x32_bf16 v[28:31], v[60:63], v[96:99], 0
    ds_read_b64_tr_b16 v[76:77], v13 offset:4096
    v_mfma_f32_16x16x32_bf16 v[44:47], v[60:63], v[100:103], 0
    ds_read_b64_tr_b16 v[78:79], v13 offset:5120
    s_waitcnt vmcnt(7) lgkmcnt(6)
    v_mfma_f32_16x16x32_bf16 v[16:19], v[64:67], v[104:107], v[16:19]
    ds_read_b64_tr_b16 v[48:49], v10 offset:8192
    s_waitcnt vmcnt(6)
    v_mfma_f32_16x16x32_bf16 v[32:35], v[64:67], v[108:111], v[32:35]
    ds_read_b64_tr_b16 v[50:51], v10 offset:9216
    s_waitcnt lgkmcnt(6)
    v_mfma_f32_16x16x32_bf16 v[20:23], v[68:71], v[104:107], v[20:23]
    ds_read_b64_tr_b16 v[52:53], v11 offset:8192
    buffer_load_dwordx4 v[136:139], v3, s[32:35], s49 offen offset:2048 sc1
    v_mfma_f32_16x16x32_bf16 v[36:39], v[68:71], v[108:111], v[36:39]
    ds_read_b64_tr_b16 v[54:55], v11 offset:9216
    s_waitcnt lgkmcnt(6)
    v_mfma_f32_16x16x32_bf16 v[24:27], v[72:75], v[104:107], v[24:27]
    ds_read_b64_tr_b16 v[56:57], v12 offset:8192
    v_mfma_f32_16x16x32_bf16 v[40:43], v[72:75], v[108:111], v[40:43]
    ds_read_b64_tr_b16 v[58:59], v12 offset:9216
    buffer_load_dwordx4 v[140:143], v3, s[32:35], s49 offen offset:3072 sc1
    s_add_u32 s49, s49, 4096
    s_waitcnt lgkmcnt(6)
    v_mfma_f32_16x16x32_bf16 v[28:31], v[76:79], v[104:107], v[28:31]
    ds_read_b64_tr_b16 v[60:61], v13 offset:8192
    v_mfma_f32_16x16x32_bf16 v[44:47], v[76:79], v[108:111], v[44:47]
    ds_read_b64_tr_b16 v[62:63], v13 offset:9216
    s_waitcnt vmcnt(7) lgkmcnt(6)
    v_mfma_f32_16x16x32_bf16 v[16:19], v[48:51], v[112:115], v[16:19]
    ds_read_b64_tr_b16 v[64:65], v10 offset:12288
    s_waitcnt vmcnt(6)
    v_mfma_f32_16x16x32_bf16 v[32:35], v[48:51], v[116:119], v[32:35]
    ds_read_b64_tr_b16 v[66:67], v10 offset:13312
    s_waitcnt lgkmcnt(6)
    v_mfma_f32_16x16x32_bf16 v[20:23], v[52:55], v[112:115], v[20:23]
    ds_read_b64_tr_b16 v[68:69], v11 offset:12288
    buffer_load_dwordx4 v[144:147], v3, s[32:35], s49 offen offset:0 sc1
    v_mfma_f32_16x16x32_bf16 v[36:39], v[52:55], v[116:119], v[36:39]
    ds_read_b64_tr_b16 v[70:71], v11 offset:13312
    s_waitcnt lgkmcnt(6)
    v_mfma_f32_16x16x32_bf16 v[24:27], v[56:59], v[112:115], v[24:27]
    ds_read_b64_tr_b16 v[72:73], v12 offset:12288
    v_mfma_f32_16x16x32_bf16 v[40:43], v[56:59], v[116:119], v[40:43]
    ds_read_b64_tr_b16 v[74:75], v12 offset:13312
    buffer_load_dwordx4 v[148:151], v3, s[32:35], s49 offen offset:1024 sc1
    s_waitcnt lgkmcnt(6)
    v_mfma_f32_16x16x32_bf16 v[28:31], v[60:63], v[112:115], v[28:31]
    ds_read_b64_tr_b16 v[76:77], v13 offset:12288
    v_mfma_f32_16x16x32_bf16 v[44:47], v[60:63], v[116:119], v[44:47]
    ds_read_b64_tr_b16 v[78:79], v13 offset:13312
    s_waitcnt vmcnt(7) lgkmcnt(6)
    v_mfma_f32_16x16x32_bf16 v[16:19], v[64:67], v[120:123], v[16:19]
    ds_read_b64_tr_b16 v[48:49], v10 offset:16384
    s_waitcnt vmcnt(6)
    v_mfma_f32_16x16x32_bf16 v[32:35], v[64:67], v[124:127], v[32:35]
    ds_read_b64_tr_b16 v[50:51], v10 offset:17408
    s_waitcnt lgkmcnt(6)
    v_mfma_f32_16x16x32_bf16 v[20:23], v[68:71], v[120:123], v[20:23]
    ds_read_b64_tr_b16 v[52:53], v11 offset:16384
    buffer_load_dwordx4 v[152:155], v3, s[32:35], s49 offen offset:2048 sc1
    v_mfma_f32_16x16x32_bf16 v[36:39], v[68:71], v[124:127], v[36:39]
    ds_read_b64_tr_b16 v[54:55], v11 offset:17408
    s_waitcnt lgkmcnt(6)
    v_mfma_f32_16x16x32_bf16 v[24:27], v[72:75], v[120:123], v[24:27]
    ds_read_b64_tr_b16 v[56:57], v12 offset:16384
    v_mfma_f32_16x16x32_bf16 v[40:43], v[72:75], v[124:127], v[40:43]
    ds_read_b64_tr_b16 v[58:59], v12 offset:17408
    buffer_load_dwordx4 v[156:159], v3, s[32:35], s49 offen offset:3072 sc1
    s_add_u32 s49, s49, 4096
    s_waitcnt lgkmcnt(6)
    v_mfma_f32_16x16x32_bf16 v[28:31], v[76:79], v[120:123], v[28:31]
    ds_read_b64_tr_b16 v[60:61], v13 offset:16384
    v_mfma_f32_16x16x32_bf16 v[44:47], v[76:79], v[124:127], v[44:47]
    ds_read_b64_tr_b16 v[62:63], v13 offset:17408
    s_waitcnt vmcnt(7) lgkmcnt(6)
    v_mfma_f32_16x16x32_bf16 v[16:19], v[48:51], v[128:131], v[16:19]
    ds_read_b64_tr_b16 v[64:65], v10 offset:20480
    s_waitcnt vmcnt(6)
    v_mfma_f32_16x16x32_bf16 v[32:35], v[48:51], v[132:135], v[32:35]
    ds_read_b64_tr_b16 v[66:67], v10 offset:21504
    s_waitcnt lgkmcnt(6)
    v_mfma_f32_16x16x32_bf16 v[20:23], v[52:55], v[128:131], v[20:23]
    ds_read_b64_tr_b16 v[68:69], v11 offset:20480
    buffer_load_dwordx4 v[160:163], v3, s[32:35], s49 offen offset:0 sc1
    v_mfma_f32_16x16x32_bf16 v[36:39], v[52:55], v[132:135], v[36:39]
    ds_read_b64_tr_b16 v[70:71], v11 offset:21504
    s_waitcnt lgkmcnt(6)
    v_mfma_f32_16x16x32_bf16 v[24:27], v[56:59], v[128:131], v[24:27]
    ds_read_b64_tr_b16 v[72:73], v12 offset:20480
    v_mfma_f32_16x16x32_bf16 v[40:43], v[56:59], v[132:135], v[40:43]
    ds_read_b64_tr_b16 v[74:75], v12 offset:21504
    buffer_load_dwordx4 v[164:167], v3, s[32:35], s49 offen offset:1024 sc1
    s_waitcnt lgkmcnt(6)
    v_mfma_f32_16x16x32_bf16 v[28:31], v[60:63], v[128:131], v[28:31]
    ds_read_b64_tr_b16 v[76:77], v13 offset:20480
    v_mfma_f32_16x16x32_bf16 v[44:47], v[60:63], v[132:135], v[44:47]
    ds_read_b64_tr_b16 v[78:79], v13 offset:21504
    s_waitcnt vmcnt(7) lgkmcnt(6)
    v_mfma_f32_16x16x32_bf16 v[16:19], v[64:67], v[136:139], v[16:19]
    ds_read_b64_tr_b16 v[48:49], v10 offset:24576
    s_waitcnt vmcnt(6)
    v_mfma_f32_16x16x32_bf16 v[32:35], v[64:67], v[140:143], v[32:35]
    ds_read_b64_tr_b16 v[50:51], v10 offset:25600
    s_waitcnt lgkmcnt(6)
    v_mfma_f32_16x16x32_bf16 v[20:23], v[68:71], v[136:139], v[20:23]
    ds_read_b64_tr_b16 v[52:53], v11 offset:24576
    buffer_load_dwordx4 v[168:171], v3, s[32:35], s49 offen offset:2048 sc1
    v_mfma_f32_16x16x32_bf16 v[36:39], v[68:71], v[140:143], v[36:39]
    ds_read_b64_tr_b16 v[54:55], v11 offset:25600
    s_waitcnt lgkmcnt(6)
    v_mfma_f32_16x16x32_bf16 v[24:27], v[72:75], v[136:139], v[24:27]
    ds_read_b64_tr_b16 v[56:57], v12 offset:24576
    v_mfma_f32_16x16x32_bf16 v[40:43], v[72:75], v[140:143], v[40:43]
    ds_read_b64_tr_b16 v[58:59], v12 offset:25600
    buffer_load_dwordx4 v[172:175], v3, s[32:35], s49 offen offset:3072 sc1
    s_add_u32 s49, s49, 4096
    s_waitcnt lgkmcnt(6)
    v_mfma_f32_16x16x32_bf16 v[28:31], v[76:79], v[136:139], v[28:31]
    ds_read_b64_tr_b16 v[60:61], v13 offset:24576
    v_mfma_f32_16x16x32_bf16 v[44:47], v[76:79], v[140:143], v[44:47]
    ds_read_b64_tr_b16 v[62:63], v13 offset:25600
    s_waitcnt vmcnt(7) lgkmcnt(6)
    v_mfma_f32_16x16x32_bf16 v[16:19], v[48:51], v[144:147], v[16:19]
    ds_read_b64_tr_b16 v[64:65], v10 offset:28672
    s_waitcnt vmcnt(6)
    v_mfma_f32_16x16x32_bf16 v[32:35], v[48:51], v[148:151], v[32:35]
    ds_read_b64_tr_b16 v[66:67], v10 offset:29696
    s_waitcnt lgkmcnt(6)
    v_mfma_f32_16x16x32_bf16 v[20:23], v[52:55], v[144:147], v[20:23]
    ds_read_b64_tr_b16 v[68:69], v11 offset:28672
    buffer_load_dwordx4 v[176:179], v3, s[32:35], s49 offen offset:0 sc1
    v_mfma_f32_16x16x32_bf16 v[36:39], v[52:55], v[148:151], v[36:39]
    ds_read_b64_tr_b16 v[70:71], v11 offset:29696
    s_waitcnt lgkmcnt(6)
    v_mfma_f32_16x16x32_bf16 v[24:27], v[56:59], v[144:147], v[24:27]
    ds_read_b64_tr_b16 v[72:73], v12 offset:28672
    v_mfma_f32_16x16x32_bf16 v[40:43], v[56:59], v[148:151], v[40:43]
    ds_read_b64_tr_b16 v[74:75], v12 offset:29696
    buffer_load_dwordx4 v[180:183], v3, s[32:35], s49 offen offset:1024 sc1
    s_waitcnt lgkmcnt(6)
    v_mfma_f32_16x16x32_bf16 v[28:31], v[60:63], v[144:147], v[28:31]
    ds_read_b64_tr_b16 v[76:77], v13 offset:28672
    v_mfma_f32_16x16x32_bf16 v[44:47], v[60:63], v[148:151], v[44:47]
    ds_read_b64_tr_b16 v[78:79], v13 offset:29696
    s_waitcnt vmcnt(7) lgkmcnt(6)
    v_mfma_f32_16x16x32_bf16 v[16:19], v[64:67], v[152:155], v[16:19]
    ds_read_b64_tr_b16 v[48:49], v10 offset:32768
    s_waitcnt vmcnt(6)
    v_mfma_f32_16x16x32_bf16 v[32:35], v[64:67], v[156:159], v[32:35]
    ds_read_b64_tr_b16 v[50:51], v10 offset:33792
    s_waitcnt lgkmcnt(6)
    v_mfma_f32_16x16x32_bf16 v[20:23], v[68:71], v[152:155], v[20:23]
    ds_read_b64_tr_b16 v[52:53], v11 offset:32768
    buffer_load_dwordx4 v[184:187], v3, s[32:35], s49 offen offset:2048 sc1
    v_mfma_f32_16x16x32_bf16 v[36:39], v[68:71], v[156:159], v[36:39]
    ds_read_b64_tr_b16 v[54:55], v11 offset:33792
    s_waitcnt lgkmcnt(6)
    v_mfma_f32_16x16x32_bf16 v[24:27], v[72:75], v[152:155], v[24:27]
    ds_read_b64_tr_b16 v[56:57], v12 offset:32768
    v_mfma_f32_16x16x32_bf16 v[40:43], v[72:75], v[156:159], v[40:43]
    ds_read_b64_tr_b16 v[58:59], v12 offset:33792
    buffer_load_dwordx4 v[188:191], v3, s[32:35], s49 offen offset:3072 sc1
    s_add_u32 s49, s49, 4096
    s_waitcnt lgkmcnt(6)
    v_mfma_f32_16x16x32_bf16 v[28:31], v[76:79], v[152:155], v[28:31]
    ds_read_b64_tr_b16 v[60:61], v13 offset:32768
    v_mfma_f32_16x16x32_bf16 v[44:47], v[76:79], v[156:159], v[44:47]
    ds_read_b64_tr_b16 v[62:63], v13 offset:33792
    s_waitcnt vmcnt(7) lgkmcnt(6)
    v_mfma_f32_16x16x32_bf16 v[16:19], v[48:51], v[160:163], v[16:19]
    ds_read_b64_tr_b16 v[64:65], v10 offset:36864
    s_waitcnt vmcnt(6)
    v_mfma_f32_16x16x32_bf16 v[32:35], v[48:51], v[164:167], v[32:35]
    ds_read_b64_tr_b16 v[66:67], v10 offset:37888
    s_waitcnt lgkmcnt(6)
    v_mfma_f32_16x16x32_bf16 v[20:23], v[52:55], v[160:163], v[20:23]
    ds_read_b64_tr_b16 v[68:69], v11 offset:36864
    buffer_load_dwordx4 v[192:195], v3, s[32:35], s49 offen offset:0 sc1
    v_mfma_f32_16x16x32_bf16 v[36:39], v[52:55], v[164:167], v[36:39]
    ds_read_b64_tr_b16 v[70:71], v11 offset:37888
    s_waitcnt lgkmcnt(6)
    v_mfma_f32_16x16x32_bf16 v[24:27], v[56:59], v[160:163], v[24:27]
    ds_read_b64_tr_b16 v[72:73], v12 offset:36864
    v_mfma_f32_16x16x32_bf16 v[40:43], v[56:59], v[164:167], v[40:43]
    ds_read_b64_tr_b16 v[74:75], v12 offset:37888
    buffer_load_dwordx4 v[196:199], v3, s[32:35], s49 offen offset:1024 sc1
    s_waitcnt lgkmcnt(6)
    v_mfma_f32_16x16x32_bf16 v[28:31], v[60:63], v[160:163], v[28:31]
    ds_read_b64_tr_b16 v[76:77], v13 offset:36864
    v_mfma_f32_16x16x32_bf16 v[44:47], v[60:63], v[164:167], v[44:47]
    ds_read_b64_tr_b16 v[78:79], v13 offset:37888
    s_waitcnt vmcnt(7) lgkmcnt(6)
    v_mfma_f32_16x16x32_bf16 v[16:19], v[64:67], v[168:171], v[16:19]
    ds_read_b64_tr_b16 v[48:49], v10 offset:40960
    s_waitcnt vmcnt(6)
    v_mfma_f32_16x16x32_bf16 v[32:35], v[64:67], v[172:175], v[32:35]
    ds_read_b64_tr_b16 v[50:51], v10 offset:41984
    s_waitcnt lgkmcnt(6)
    v_mfma_f32_16x16x32_bf16 v[20:23], v[68:71], v[168:171], v[20:23]
    ds_read_b64_tr_b16 v[52:53], v11 offset:40960
    buffer_load_dwordx4 v[200:203], v3, s[32:35], s49 offen offset:2048 sc1
    v_mfma_f32_16x16x32_bf16 v[36:39], v[68:71], v[172:175], v[36:39]
    ds_read_b64_tr_b16 v[54:55], v11 offset:41984
    s_waitcnt lgkmcnt(6)
    v_mfma_f32_16x16x32_bf16 v[24:27], v[72:75], v[168:171], v[24:27]
    ds_read_b64_tr_b16 v[56:57], v12 offset:40960
    v_mfma_f32_16x16x32_bf16 v[40:43], v[72:75], v[172:175], v[40:43]
    ds_read_b64_tr_b16 v[58:59], v12 offset:41984
    buffer_load_dwordx4 v[204:207], v3, s[32:35], s49 offen offset:3072 sc1
    s_add_u32 s49, s49, 4096
    s_waitcnt lgkmcnt(6)
    v_mfma_f32_16x16x32_bf16 v[28:31], v[76:79], v[168:171], v[28:31]
    ds_read_b64_tr_b16 v[60:61], v13 offset:40960
    v_mfma_f32_16x16x32_bf16 v[44:47], v[76:79], v[172:175], v[44:47]
    ds_read_b64_tr_b16 v[62:63], v13 offset:41984
    s_waitcnt vmcnt(7) lgkmcnt(6)
    v_mfma_f32_16x16x32_bf16 v[16:19], v[48:51], v[176:179], v[16:19]
    ds_read_b64_tr_b16 v[64:65], v10 offset:45056
    s_waitcnt vmcnt(6)
    v_mfma_f32_16x16x32_bf16 v[32:35], v[48:51], v[180:183], v[32:35]
    ds_read_b64_tr_b16 v[66:67], v10 offset:46080
    s_waitcnt lgkmcnt(6)
    v_mfma_f32_16x16x32_bf16 v[20:23], v[52:55], v[176:179], v[20:23]
    ds_read_b64_tr_b16 v[68:69], v11 offset:45056
    buffer_load_dwordx4 v[208:211], v3, s[32:35], s49 offen offset:0 sc1
    v_mfma_f32_16x16x32_bf16 v[36:39], v[52:55], v[180:183], v[36:39]
    ds_read_b64_tr_b16 v[70:71], v11 offset:46080
    s_waitcnt lgkmcnt(6)
    v_mfma_f32_16x16x32_bf16 v[24:27], v[56:59], v[176:179], v[24:27]
    ds_read_b64_tr_b16 v[72:73], v12 offset:45056
    v_mfma_f32_16x16x32_bf16 v[40:43], v[56:59], v[180:183], v[40:43]
    ds_read_b64_tr_b16 v[74:75], v12 offset:46080
    buffer_load_dwordx4 v[212:215], v3, s[32:35], s49 offen offset:1024 sc1
    s_waitcnt lgkmcnt(6)
    v_mfma_f32_16x16x32_bf16 v[28:31], v[60:63], v[176:179], v[28:31]
    ds_read_b64_tr_b16 v[76:77], v13 offset:45056
    v_mfma_f32_16x16x32_bf16 v[44:47], v[60:63], v[180:183], v[44:47]
    ds_read_b64_tr_b16 v[78:79], v13 offset:46080
    s_waitcnt vmcnt(7) lgkmcnt(6)
    v_mfma_f32_16x16x32_bf16 v[16:19], v[64:67], v[184:187], v[16:19]
    ds_read_b64_tr_b16 v[48:49], v10 offset:49152
    s_waitcnt vmcnt(6)
    v_mfma_f32_16x16x32_bf16 v[32:35], v[64:67], v[188:191], v[32:35]
    ds_read_b64_tr_b16 v[50:51], v10 offset:50176
    s_waitcnt lgkmcnt(6)
    v_mfma_f32_16x16x32_bf16 v[20:23], v[68:71], v[184:187], v[20:23]
    ds_read_b64_tr_b16 v[52:53], v11 offset:49152
    buffer_load_dwordx4 v[216:219], v3, s[32:35], s49 offen offset:2048 sc1
    v_mfma_f32_16x16x32_bf16 v[36:39], v[68:71], v[188:191], v[36:39]
    ds_read_b64_tr_b16 v[54:55], v11 offset:50176
    s_waitcnt lgkmcnt(6)
    v_mfma_f32_16x16x32_bf16 v[24:27], v[72:75], v[184:187], v[24:27]
    ds_read_b64_tr_b16 v[56:57], v12 offset:49152
    v_mfma_f32_16x16x32_bf16 v[40:43], v[72:75], v[188:191], v[40:43]
    ds_read_b64_tr_b16 v[58:59], v12 offset:50176
    buffer_load_dwordx4 v[220:223], v3, s[32:35], s49 offen offset:3072 sc1
    s_add_u32 s49, s49, 4096
    s_waitcnt lgkmcnt(6)
    v_mfma_f32_16x16x32_bf16 v[28:31], v[76:79], v[184:187], v[28:31]
    ds_read_b64_tr_b16 v[60:61], v13 offset:49152
    v_mfma_f32_16x16x32_bf16 v[44:47], v[76:79], v[188:191], v[44:47]
    ds_read_b64_tr_b16 v[62:63], v13 offset:50176
    s_waitcnt vmcnt(7) lgkmcnt(6)
    v_mfma_f32_16x16x32_bf16 v[16:19], v[48:51], v[192:195], v[16:19]
    ds_read_b64_tr_b16 v[64:65], v10 offset:53248
    s_waitcnt vmcnt(6)
    v_mfma_f32_16x16x32_bf16 v[32:35], v[48:51], v[196:199], v[32:35]
    ds_read_b64_tr_b16 v[66:67], v10 offset:54272
    s_waitcnt lgkmcnt(6)
    v_mfma_f32_16x16x32_bf16 v[20:23], v[52:55], v[192:195], v[20:23]
    ds_read_b64_tr_b16 v[68:69], v11 offset:53248
    v_mfma_f32_16x16x32_bf16 v[36:39], v[52:55], v[196:199], v[36:39]
    ds_read_b64_tr_b16 v[70:71], v11 offset:54272
    s_waitcnt lgkmcnt(6)
    v_mfma_f32_16x16x32_bf16 v[24:27], v[56:59], v[192:195], v[24:27]
    ds_read_b64_tr_b16 v[72:73], v12 offset:53248
    v_mfma_f32_16x16x32_bf16 v[40:43], v[56:59], v[196:199], v[40:43]
    ds_read_b64_tr_b16 v[74:75], v12 offset:54272
    s_waitcnt lgkmcnt(6)
    v_mfma_f32_16x16x32_bf16 v[28:31], v[60:63], v[192:195], v[28:31]
    ds_read_b64_tr_b16 v[76:77], v13 offset:53248
    v_mfma_f32_16x16x32_bf16 v[44:47], v[60:63], v[196:199], v[44:47]
    ds_read_b64_tr_b16 v[78:79], v13 offset:54272
    s_waitcnt vmcnt(5) lgkmcnt(6)
    v_mfma_f32_16x16x32_bf16 v[16:19], v[64:67], v[200:203], v[16:19]
    ds_read_b64_tr_b16 v[48:49], v10 offset:57344
    s_waitcnt vmcnt(4)
    v_mfma_f32_16x16x32_bf16 v[32:35], v[64:67], v[204:207], v[32:35]
    ds_read_b64_tr_b16 v[50:51], v10 offset:58368
    s_waitcnt lgkmcnt(6)
    v_mfma_f32_16x16x32_bf16 v[20:23], v[68:71], v[200:203], v[20:23]
    ds_read_b64_tr_b16 v[52:53], v11 offset:57344
    v_mfma_f32_16x16x32_bf16 v[36:39], v[68:71], v[204:207], v[36:39]
    ds_read_b64_tr_b16 v[54:55], v11 offset:58368
    s_waitcnt lgkmcnt(6)
    v_mfma_f32_16x16x32_bf16 v[24:27], v[72:75], v[200:203], v[24:27]
    ds_read_b64_tr_b16 v[56:57], v12 offset:57344
    v_mfma_f32_16x16x32_bf16 v[40:43], v[72:75], v[204:207], v[40:43]
    ds_read_b64_tr_b16 v[58:59], v12 offset:58368
    s_waitcnt lgkmcnt(6)
    v_mfma_f32_16x16x32_bf16 v[28:31], v[76:79], v[200:203], v[28:31]
    ds_read_b64_tr_b16 v[60:61], v13 offset:57344
    v_mfma_f32_16x16x32_bf16 v[44:47], v[76:79], v[204:207], v[44:47]
    ds_read_b64_tr_b16 v[62:63], v13 offset:58368
    s_waitcnt vmcnt(3) lgkmcnt(6)
    v_mfma_f32_16x16x32_bf16 v[16:19], v[48:51], v[208:211], v[16:19]
    ds_read_b64_tr_b16 v[64:65], v10 offset:61440
    s_waitcnt vmcnt(2)
    v_mfma_f32_16x16x32_bf16 v[32:35], v[48:51], v[212:215], v[32:35]
    ds_read_b64_tr_b16 v[66:67], v10 offset:62464
    s_waitcnt lgkmcnt(6)
    v_mfma_f32_16x16x32_bf16 v[20:23], v[52:55], v[208:211], v[20:23]
    ds_read_b64_tr_b16 v[68:69], v11 offset:61440
    v_mfma_f32_16x16x32_bf16 v[36:39], v[52:55], v[212:215], v[36:39]
    ds_read_b64_tr_b16 v[70:71], v11 offset:62464
    s_waitcnt lgkmcnt(6)
    v_mfma_f32_16x16x32_bf16 v[24:27], v[56:59], v[208:211], v[24:27]
    ds_read_b64_tr_b16 v[72:73], v12 offset:61440
    v_mfma_f32_16x16x32_bf16 v[40:43], v[56:59], v[212:215], v[40:43]
    ds_read_b64_tr_b16 v[74:75], v12 offset:62464
    s_waitcnt lgkmcnt(6)
    v_mfma_f32_16x16x32_bf16 v[28:31], v[60:63], v[208:211], v[28:31]
    ds_read_b64_tr_b16 v[76:77], v13 offset:61440
    v_mfma_f32_16x16x32_bf16 v[44:47], v[60:63], v[212:215], v[44:47]
    ds_read_b64_tr_b16 v[78:79], v13 offset:62464
    s_waitcnt vmcnt(1) lgkmcnt(6)
    v_mfma_f32_16x16x32_bf16 v[16:19], v[64:67], v[216:219], v[16:19]
    s_waitcnt vmcnt(0)
    v_mfma_f32_16x16x32_bf16 v[32:35], v[64:67], v[220:223], v[32:35]
    s_waitcnt lgkmcnt(4)
    v_mfma_f32_16x16x32_bf16 v[20:23], v[68:71], v[216:219], v[20:23]
    v_mfma_f32_16x16x32_bf16 v[36:39], v[68:71], v[220:223], v[36:39]
    s_waitcnt lgkmcnt(2)
    v_mfma_f32_16x16x32_bf16 v[24:27], v[72:75], v[216:219], v[24:27]
    v_mfma_f32_16x16x32_bf16 v[40:43], v[72:75], v[220:223], v[40:43]
    s_waitcnt lgkmcnt(0)
    v_mfma_f32_16x16x32_bf16 v[28:31], v[76:79], v[216:219], v[28:31]
    v_mfma_f32_16x16x32_bf16 v[44:47], v[76:79], v[220:223], v[44:47]
    v_and_b32 v14, 1, v2
    v_lshl_add_u32 v14, v14, 3, v0
    s_add_u32 s59, s60, 2
Lw_120:
    ds_read_b32 v15, v14 offset:17456
    s_waitcnt lgkmcnt(0)
    v_cmp_ne_u32 vcc, s59, v15
    s_cbranch_vccnz Lw_120
    s_cmp_eq_u32 s45, 1
    s_cbranch_scc1 L_h3_p1
    ds_write_b128 v4, v[32:35] offset:0
    ds_write_b128 v4, v[36:39] offset:1024
    ds_write_b128 v4, v[40:43] offset:2048
    ds_write_b128 v4, v[44:47] offset:3072
    s_add_u32 s58, s60, 1
    v_mov_b32 v14, s58
    ds_write_b32 v0, v14 offset:17568
    s_add_u32 s59, s60, 1
Lw_121:
    ds_read_b32 v15, v0 offset:17576
    s_waitcnt lgkmcnt(0)
    v_cmp_ne_u32 vcc, s59, v15
    s_cbranch_vccnz Lw_121
    ds_read_b128 v[96:99], v4 offset:4096
    ds_read_b128 v[100:103], v4 offset:5120
    ds_read_b128 v[104:107], v4 offset:6144
    ds_read_b128 v[108:111], v4 offset:7168
    s_waitcnt lgkmcnt(0)
    ds_write_b32 v0, v14 offset:17584
    v_pk_add_f32 v[16:17], v[16:17], v[96:97]
    v_pk_add_f32 v[18:19], v[18:19], v[98:99]
    v_pk_add_f32 v[20:21], v[20:21], v[100:101]
    v_pk_add_f32 v[22:23], v[22:23], v[102:103]
    v_pk_add_f32 v[24:25], v[24:25], v[104:105]
    v_pk_add_f32 v[26:27], v[26:27], v[106:107]
    v_pk_add_f32 v[28:29], v[28:29], v[108:109]
    v_pk_add_f32 v[30:31], v[30:31], v[110:111]
    v_cvt_pk_bf16_f32 v64, v16, v17
    v_cvt_pk_bf16_f32 v66, v20, v21
    v_cvt_pk_bf16_f32 v65, v18, v19
    v_cvt_pk_bf16_f32 v67, v22, v23
    v_cvt_pk_bf16_f32 v68, v24, v25
    v_cvt_pk_bf16_f32 v70, v28, v29
    v_cvt_pk_bf16_f32 v69, v26, v27
    v_cvt_pk_bf16_f32 v71, v30, v31
    s_nop 1
    v_permlane16_swap_b32 v64, v66
    v_permlane16_swap_b32 v65, v67
    v_permlane16_swap_b32 v68, v70
    v_permlane16_swap_b32 v69, v71
    s_mov_b32 s51, 0x8000
    buffer_store_dwordx4 v[64:67], v5, s[28:31], 0 offen offset:0 sc1
    buffer_store_dwordx4 v[68:71], v5, s[28:31], 0 offen offset:64 sc1
    s_branch L_fin
L_h3_p1:
    ds_write_b128 v4, v[16:19] offset:4096
    ds_write_b128 v4, v[20:23] offset:5120
    ds_write_b128 v4, v[24:27] offset:6144
    ds_write_b128 v4, v[28:31] offset:7168
    s_add_u32 s58, s60, 1
    v_mov_b32 v14, s58
    ds_write_b32 v0, v14 offset:17576
    s_add_u32 s59, s60, 1
Lw_122:
    ds_read_b32 v15, v0 offset:17568
    s_waitcnt lgkmcnt(0)
    v_cmp_ne_u32 vcc, s59, v15
    s_cbranch_vccnz Lw_122
    ds_read_b128 v[96:99], v4 offset:0
    ds_read_b128 v[100:103], v4 offset:1024
    ds_read_b128 v[104:107], v4 offset:2048
    ds_read_b128 v[108:111], v4 offset:3072
    s_waitcnt lgkmcnt(0)
    ds_write_b32 v0, v14 offset:17592
    v_pk_add_f32 v[32:33], v[32:33], v[96:97]
    v_pk_add_f32 v[34:35], v[34:35], v[98:99]
    v_pk_add_f32 v[36:37], v[36:37], v[100:101]
    v_pk_add_f32 v[38:39], v[38:39], v[102:103]
    v_pk_add_f32 v[40:41], v[40:41], v[104:105]
    v_pk_add_f32 v[42:43], v[42:43], v[106:107]
    v_pk_add_f32 v[44:45], v[44:45], v[108:109]
    v_pk_add_f32 v[46:47], v[46:47], v[110:111]
    v_cvt_pk_bf16_f32 v64, v32, v33
    v_cvt_pk_bf16_f32 v66, v36, v37
    v_cvt_pk_bf16_f32 v65, v34, v35
    v_cvt_pk_bf16_f32 v67, v38, v39
    v_cvt_pk_bf16_f32 v68, v40, v41
    v_cvt_pk_bf16_f32 v70, v44, v45
    v_cvt_pk_bf16_f32 v69, v42, v43
    v_cvt_pk_bf16_f32 v71, v46, v47
    s_nop 1
    v_permlane16_swap_b32 v64, v66
    v_permlane16_swap_b32 v65, v67
    v_permlane16_swap_b32 v68, v70
    v_permlane16_swap_b32 v69, v71
    s_mov_b32 s51, 0x8000
    buffer_store_dwordx4 v[64:67], v5, s[28:31], 0 offen offset:0 sc1
    buffer_store_dwordx4 v[68:71], v5, s[28:31], 0 offen offset:64 sc1
    s_branch L_fin
L_fin:
L_end:
    s_endpgm
L_code_end:
.section .rodata,"a"
.p2align 6
.amdhsa_kernel standalone__sliding_block__prompt_kernel
  .amdhsa_next_free_vgpr 256
  .amdhsa_next_free_sgpr 102
  .amdhsa_accum_offset 256
  .amdhsa_group_segment_fixed_size 0
  .amdhsa_kernarg_size 48
  .amdhsa_user_sgpr_count 2
  .amdhsa_user_sgpr_kernarg_segment_ptr 1
  .amdhsa_system_sgpr_workgroup_id_x 1
.end_amdhsa_kernel
```
